```python
import torch

def _softmax(x, axis=-1):
    return torch.softmax(x, dim=axis)
def _gelu(x):
    return torch.nn.functional.gelu(x, approximate="tanh")
def _silu(x):
    return torch.nn.functional.silu(x)
def _sigmoid(x):
    return torch.sigmoid(x)
def _layernorm(x, axis=-1, eps=1e-5):
    m = x.mean(dim=axis, keepdim=True)
    v = x.var(dim=axis, keepdim=True, unbiased=False)
    return (x - m) / torch.sqrt(v + eps)
def _scatter_add(tgt, idx, src, axis=0):
    return tgt.clone().index_add_(axis, idx, src)
def _segment_sum(src, seg, n):
    out = torch.zeros((n,) + src.shape[1:], dtype=src.dtype)
    return out.index_add_(0, seg, src)
def _pad(x, pw):
    flat = tuple(v for pair in reversed(pw) for v in pair)
    return torch.nn.functional.pad(x, flat)

kernel_name = 'sequential_preLN__sliding_block_cached__glu_gated_geglu__decode'

def setup_inputs():

    _w = (lambda a: (lambda t: t.to(torch.bfloat16) if t.is_floating_point() else t)(torch.as_tensor(a)))
    def _A_setup():
        B, Sq, D = 1, 1, 576
        Hq, Hkv, Sk, Dh = 32, 16, 65536, 128
        assert Hq % Hkv == 0, (Hq, Hkv)
        return {
            "x": _w((lambda *s: torch.randn(*s, dtype=torch.bfloat16) * 0.05)(B, Sq, D)),
            "k_cache": _w((lambda *s: torch.randn(*s, dtype=torch.bfloat16) * 1.6)(B, Hkv, Sk, Dh)),
            "v_cache": _w((lambda *s: torch.randn(*s, dtype=torch.bfloat16) * 0.8)(B, Hkv, Sk, Dh)),
            "wq": _w((lambda *s: torch.randn(*s, dtype=torch.bfloat16) * 1.6)(D, Hq * Dh) * (D ** -0.5)),
            "wo": _w((lambda *s: torch.randn(*s, dtype=torch.bfloat16) * 0.8)(Hq * Dh, D) * ((Hq * Dh) ** -0.5)),
        }
    _A_in = _A_setup()

    def _B_setup():
        B, S, Dm, Df = 1, 1, 576, 4608
        return {
            "x": _w((lambda *s: torch.randn(*s, dtype=torch.bfloat16) * 0.05)(B, S, Dm)),
            "w_gate": _w((lambda *s: torch.randn(*s, dtype=torch.bfloat16) * 0.4)(Dm, Df) * (Dm ** -0.5)),
            "w_up": _w((lambda *s: torch.randn(*s, dtype=torch.bfloat16) * 0.4)(Dm, Df) * (Dm ** -0.5)),
            "w_down": _w((lambda *s: torch.randn(*s, dtype=torch.bfloat16) * 0.4)(Df, Dm) * (Df ** -0.5)),
        }
    _B_in = _B_setup()

    return {
        "A_x": _A_in["x"],
        "A_k_cache": _A_in["k_cache"],
        "A_v_cache": _A_in["v_cache"],
        "A_wq": _A_in["wq"],
        "A_wo": _A_in["wo"],
        "B_x": _B_in["x"],
        "B_w_gate": _B_in["w_gate"],
        "B_w_up": _B_in["w_up"],
        "B_w_down": _B_in["w_down"],
    }

def reference(A_x, A_k_cache, A_v_cache, A_wq, A_wo, B_x, B_w_gate, B_w_up, B_w_down):
    def _A_ref(x, k_cache, v_cache, wq, wo):
        B, Sq, D = x.shape
        Hq, Dh = 32, 128
        Hkv, Sk = k_cache.shape[1], k_cache.shape[2]
        W = min(4096, max(256, Sk // 4))
        rep = Hq // Hkv
        q = (lambda x, *d: x.permute(*d))((x @ wq).reshape(B, Sq, Hq, Dh), 0, 2, 1, 3)
        k = (lambda x, n, axis: torch.repeat_interleave(x, n, dim=axis))(k_cache[:, :, Sk - W:, :], rep, axis=1)
        v = (lambda x, n, axis: torch.repeat_interleave(x, n, dim=axis))(v_cache[:, :, Sk - W:, :], rep, axis=1)
        scores = torch.einsum("bhqd,bhkd->bhqk", q, k) * (Dh ** -0.5)
        p = _softmax(scores, axis=-1)
        o = torch.einsum("bhqk,bhkd->bhqd", p, v)
        return (lambda x, *d: x.permute(*d))(o, 0, 2, 1, 3).reshape(B, Sq, Hq * Dh) @ wo

    def _B_ref(x, w_gate, w_up, w_down):
        g = torch.einsum("bsd,df->bsf", x, w_gate)
        u = torch.einsum("bsd,df->bsf", x, w_up)
        h = _gelu(g) * u
        return torch.einsum("bsf,fd->bsd", h, w_down)

    x = A_x
    h = x + _A_ref(_layernorm(x, axis=-1), A_k_cache, A_v_cache, A_wq, A_wo)
    h2 = h + _B_ref(_layernorm(h, axis=-1), B_w_gate, B_w_up, B_w_down)
    return h2
```

```asm
; @launch grid=(256,1,1) block=(1024,1,1) lds=13568
.amdgcn_target "amdgcn-amd-amdhsa--gfx950"
.text
.globl sequential_preLN__sliding_block_cached__glu_gated_geglu__decode_kernel
.p2align 8
.type sequential_preLN__sliding_block_cached__glu_gated_geglu__decode_kernel,@function
sequential_preLN__sliding_block_cached__glu_gated_geglu__decode_kernel:
s_cmp_ge_u32 s2, 256
s_cbranch_scc1 L_exit
s_load_dwordx16 s[4:19], s[0:1], 0
s_load_dwordx8 s[20:27], s[0:1], 64
v_and_b32 v1, 63, v0
v_lshrrev_b32 v3, 6, v0
v_lshlrev_b32 v4, 2, v0
v_readfirstlane_b32 s28, v3
v_mov_b32 v6, 0
v_mov_b32 v5, 0xff800000
v_and_b32 v7, 0x3fe, v0
v_cmp_eq_u32 vcc, 4, v7
v_mov_b32 v2, 0
v_mov_b32 v11, 1
v_cndmask_b32 v6, v6, v5, vcc
ds_write_b32 v4, v6
s_and_b32 s29, s2, 7
s_lshr_b32 s30, s2, 3
s_and_b32 s35, s30, 1
s_lshl_b32 s31, s29, 1
s_or_b32 s31, s31, s35
s_lshr_b32 s32, s30, 1
s_and_b32 s92, s32, 3
s_lshr_b32 s93, s32, 2
s_mul_i32 s94, s93, 3
s_add_u32 s94, s94, s92
s_sub_u32 s94, s94, 1
s_lshl_b32 s94, s94, 1
s_add_u32 s94, s94, s35
s_mul_i32 s33, s29, 24
s_add_u32 s33, s33, s94
s_mov_b32 s34, 262144
v_and_b32 v3, 1, v1
v_cmp_eq_u32 vcc, 1, v3
v_mov_b32 v4, 0xffff
v_mov_b32 v5, 0xffff0000
v_cndmask_b32 v5, v4, v5, vcc
v_bfe_u32 v3, v1, 1, 2
v_cmp_eq_u32 vcc, 0, v3
s_nop 1
v_cndmask_b32 v12, 0, v5, vcc
v_cmp_eq_u32 vcc, 1, v3
s_nop 1
v_cndmask_b32 v13, 0, v5, vcc
v_cmp_eq_u32 vcc, 2, v3
s_nop 1
v_cndmask_b32 v14, 0, v5, vcc
v_cmp_eq_u32 vcc, 3, v3
s_nop 1
v_cndmask_b32 v15, 0, v5, vcc
s_cmp_lt_u32 s28, 8
s_cbranch_scc1 L_A
s_cmp_lt_u32 s28, 14
s_cbranch_scc1 L_W
s_cmp_eq_u32 s28, 14
s_cbranch_scc1 L_C
s_branch L_H
L_A:
s_add_u32 s49, s32, 3
s_lshr_b32 s49, s49, 2
s_sub_u32 s50, s32, s49
s_mul_i32 s49, s49, 40
s_mul_i32 s50, s50, 72
s_add_u32 s49, s49, s50
s_add_u32 s49, s49, s28
s_lshl_b32 s49, s49, 10
s_lshl_b32 s48, s31, 24
s_add_u32 s48, s48, s49
s_add_u32 s48, s48, 15728640
v_bfe_u32 v3, v1, 2, 2
v_lshlrev_b32 v3, 8, v3
v_lshrrev_b32 v4, 4, v1
v_lshl_add_u32 v3, v4, 6, v3
v_and_b32 v4, 3, v1
v_lshl_add_u32 v3, v4, 4, v3
v_lshlrev_b32 v4, 4, v1
s_cmp_eq_u32 s92, 0
s_cbranch_scc1 L_AO
s_waitcnt lgkmcnt(0)
s_add_u32 s36, s6, s48
s_addc_u32 s37, s7, 0
s_and_b32 s37, s37, 0xffff
s_mov_b32 s38, 66560
s_mov_b32 s39, 0x20000
s_add_u32 s40, s8, s48
s_addc_u32 s41, s9, 0
s_and_b32 s41, s41, 0xffff
s_mov_b32 s42, 66560
s_mov_b32 s43, 0x20000
s_barrier
s_mov_b32 s49, 0
buffer_load_dwordx4 v[40:43], v3, s[36:39], s49 offen nt
s_mov_b32 s49, 8192
buffer_load_dwordx4 v[44:47], v3, s[36:39], s49 offen nt
s_mov_b32 s49, 16384
buffer_load_dwordx4 v[48:51], v3, s[36:39], s49 offen nt
s_waitcnt vmcnt(2)
s_mov_b32 s49, 24576
buffer_load_dwordx4 v[52:55], v3, s[36:39], s49 offen nt
s_waitcnt vmcnt(2)
s_mov_b32 s49, 32768
buffer_load_dwordx4 v[56:59], v3, s[36:39], s49 offen nt
s_waitcnt vmcnt(2)
s_mov_b32 s49, 40960
buffer_load_dwordx4 v[60:63], v3, s[36:39], s49 offen nt
s_waitcnt vmcnt(2)
s_mov_b32 s49, 49152
buffer_load_dwordx4 v[64:67], v3, s[36:39], s49 offen nt
s_waitcnt vmcnt(2)
s_mov_b32 s49, 57344
buffer_load_dwordx4 v[68:71], v3, s[36:39], s49 offen nt
s_waitcnt vmcnt(2)
s_mov_b32 s49, 65536
buffer_load_dwordx4 v[72:75], v3, s[36:39], s49 offen nt
s_waitcnt vmcnt(3)
s_mov_b32 s49, 0
buffer_load_dwordx4 v[76:79], v4, s[40:43], s49 offen nt
s_mov_b64 exec, 1
ds_add_u32 v2, v11 offset:104
s_mov_b64 exec, -1
s_waitcnt vmcnt(3)
s_mov_b32 s49, 8192
buffer_load_dwordx4 v[80:83], v4, s[40:43], s49 offen nt
s_waitcnt vmcnt(3)
s_mov_b32 s49, 16384
buffer_load_dwordx4 v[84:87], v4, s[40:43], s49 offen nt
s_waitcnt vmcnt(3)
s_mov_b32 s49, 24576
buffer_load_dwordx4 v[88:91], v4, s[40:43], s49 offen nt
s_waitcnt vmcnt(3)
s_mov_b32 s49, 32768
buffer_load_dwordx4 v[92:95], v4, s[40:43], s49 offen nt
s_waitcnt vmcnt(3)
s_mov_b32 s49, 40960
buffer_load_dwordx4 v[96:99], v4, s[40:43], s49 offen nt
s_waitcnt vmcnt(3)
s_mov_b32 s49, 49152
buffer_load_dwordx4 v[100:103], v4, s[40:43], s49 offen nt
s_waitcnt vmcnt(3)
s_mov_b32 s49, 57344
buffer_load_dwordx4 v[104:107], v4, s[40:43], s49 offen nt
s_waitcnt vmcnt(3)
s_mov_b32 s49, 65536
buffer_load_dwordx4 v[108:111], v4, s[40:43], s49 offen nt
s_mov_b64 exec, 1
ds_add_u32 v2, v11 offset:8
s_mov_b64 exec, -1
v_bfe_u32 v5, v1, 3, 1
v_cmp_eq_u32 s[50:51], 1, v5
v_lshlrev_b32 v5, 8, v5
v_lshrrev_b32 v6, 4, v1
v_lshl_add_u32 v5, v6, 6, v5
v_and_b32 v6, 3, v1
v_lshl_add_u32 v5, v6, 4, v5
s_lshl_b32 s35, s28, 10
v_lshl_add_u32 v7, v1, 4, s35
v_bfe_u32 v8, v1, 3, 1
v_lshlrev_b32 v8, 2, v8
L_w_1:
ds_read_b32 v3, v2 offset:4
ds_read_b128 v[32:35], v5 offset:2048
ds_read_b32 v10, v2 offset:100
s_waitcnt lgkmcnt(0)
v_readfirstlane_b32 s35, v3
s_nop 0
s_cmp_ge_u32 s35, 1
s_cbranch_scc1 L_wd_2
s_sleep 1
s_sub_u32 s34, s34, 1
s_cbranch_scc0 L_w_1
s_branch L_end
L_wd_2:
s_waitcnt vmcnt(17)
v_mfma_f32_16x16x32_bf16 v[40:43], v[40:43], v[32:35], 0
s_waitcnt vmcnt(16)
v_mfma_f32_16x16x32_bf16 v[44:47], v[44:47], v[32:35], 0
s_waitcnt vmcnt(15)
v_mfma_f32_16x16x32_bf16 v[48:51], v[48:51], v[32:35], 0
s_nop 3
v_mov_b32_dpp v16, v40 quad_perm:[0,0,0,0] row_mask:0xf bank_mask:0xf
v_add_f32_dpp v16, v41, v16 quad_perm:[1,1,1,1] row_mask:0xf bank_mask:0xf
v_add_f32_dpp v16, v42, v16 quad_perm:[2,2,2,2] row_mask:0xf bank_mask:0xf
v_add_f32_dpp v16, v43, v16 quad_perm:[3,3,3,3] row_mask:0xf bank_mask:0xf
s_waitcnt vmcnt(14)
v_mfma_f32_16x16x32_bf16 v[52:55], v[52:55], v[32:35], 0
v_mov_b32_dpp v17, v44 quad_perm:[0,0,0,0] row_mask:0xf bank_mask:0xf
v_add_f32_dpp v17, v45, v17 quad_perm:[1,1,1,1] row_mask:0xf bank_mask:0xf
v_add_f32_dpp v17, v46, v17 quad_perm:[2,2,2,2] row_mask:0xf bank_mask:0xf
v_add_f32_dpp v17, v47, v17 quad_perm:[3,3,3,3] row_mask:0xf bank_mask:0xf
s_waitcnt vmcnt(13)
v_mfma_f32_16x16x32_bf16 v[56:59], v[56:59], v[32:35], 0
v_mov_b32_dpp v18, v48 quad_perm:[0,0,0,0] row_mask:0xf bank_mask:0xf
v_add_f32_dpp v18, v49, v18 quad_perm:[1,1,1,1] row_mask:0xf bank_mask:0xf
v_add_f32_dpp v18, v50, v18 quad_perm:[2,2,2,2] row_mask:0xf bank_mask:0xf
v_add_f32_dpp v18, v51, v18 quad_perm:[3,3,3,3] row_mask:0xf bank_mask:0xf
s_waitcnt vmcnt(12)
v_mfma_f32_16x16x32_bf16 v[60:63], v[60:63], v[32:35], 0
v_mov_b32_dpp v19, v52 quad_perm:[0,0,0,0] row_mask:0xf bank_mask:0xf
v_add_f32_dpp v19, v53, v19 quad_perm:[1,1,1,1] row_mask:0xf bank_mask:0xf
v_add_f32_dpp v19, v54, v19 quad_perm:[2,2,2,2] row_mask:0xf bank_mask:0xf
v_add_f32_dpp v19, v55, v19 quad_perm:[3,3,3,3] row_mask:0xf bank_mask:0xf
s_waitcnt vmcnt(11)
v_mfma_f32_16x16x32_bf16 v[64:67], v[64:67], v[32:35], 0
v_mov_b32_dpp v20, v56 quad_perm:[0,0,0,0] row_mask:0xf bank_mask:0xf
v_add_f32_dpp v20, v57, v20 quad_perm:[1,1,1,1] row_mask:0xf bank_mask:0xf
v_add_f32_dpp v20, v58, v20 quad_perm:[2,2,2,2] row_mask:0xf bank_mask:0xf
v_add_f32_dpp v20, v59, v20 quad_perm:[3,3,3,3] row_mask:0xf bank_mask:0xf
s_waitcnt vmcnt(10)
v_mfma_f32_16x16x32_bf16 v[68:71], v[68:71], v[32:35], 0
v_mov_b32_dpp v21, v60 quad_perm:[0,0,0,0] row_mask:0xf bank_mask:0xf
v_add_f32_dpp v21, v61, v21 quad_perm:[1,1,1,1] row_mask:0xf bank_mask:0xf
v_add_f32_dpp v21, v62, v21 quad_perm:[2,2,2,2] row_mask:0xf bank_mask:0xf
v_add_f32_dpp v21, v63, v21 quad_perm:[3,3,3,3] row_mask:0xf bank_mask:0xf
s_waitcnt vmcnt(9)
v_mfma_f32_16x16x32_bf16 v[72:75], v[72:75], v[32:35], 0
v_mov_b32_dpp v22, v64 quad_perm:[0,0,0,0] row_mask:0xf bank_mask:0xf
v_add_f32_dpp v22, v65, v22 quad_perm:[1,1,1,1] row_mask:0xf bank_mask:0xf
v_add_f32_dpp v22, v66, v22 quad_perm:[2,2,2,2] row_mask:0xf bank_mask:0xf
v_add_f32_dpp v22, v67, v22 quad_perm:[3,3,3,3] row_mask:0xf bank_mask:0xf
s_nop 1
v_mov_b32_dpp v23, v68 quad_perm:[0,0,0,0] row_mask:0xf bank_mask:0xf
v_add_f32_dpp v23, v69, v23 quad_perm:[1,1,1,1] row_mask:0xf bank_mask:0xf
v_add_f32_dpp v23, v70, v23 quad_perm:[2,2,2,2] row_mask:0xf bank_mask:0xf
v_add_f32_dpp v23, v71, v23 quad_perm:[3,3,3,3] row_mask:0xf bank_mask:0xf
v_mov_b32_dpp v24, v72 quad_perm:[0,0,0,0] row_mask:0xf bank_mask:0xf
v_add_f32_dpp v24, v73, v24 quad_perm:[1,1,1,1] row_mask:0xf bank_mask:0xf
v_add_f32_dpp v24, v74, v24 quad_perm:[2,2,2,2] row_mask:0xf bank_mask:0xf
v_add_f32_dpp v24, v75, v24 quad_perm:[3,3,3,3] row_mask:0xf bank_mask:0xf
v_max3_f32 v3, v16, v17, v18
v_max3_f32 v3, v3, v19, v20
v_max3_f32 v3, v3, v21, v22
v_max3_f32 v3, v3, v23, v24
s_mov_b32 s52, 0x01010101
s_mov_b32 s53, 0x01010101
s_mov_b64 exec, s[52:53]
ds_max_f32 v8, v3 offset:16
s_mov_b64 exec, 1
ds_add_u32 v2, v11 offset:24
s_mov_b64 exec, -1
s_mov_b32 s48, s28
v_lshrrev_b32 v31, 4, v1
v_lshlrev_b32 v31, 1, v31
v_bfe_u32 v3, v1, 3, 1
v_add_u32 v31, v31, v3
v_and_b32 v30, 1, v1
v_lshlrev_b32 v30, 6, v30
v_bfe_u32 v3, v1, 2, 1
v_lshl_add_u32 v30, v3, 5, v30
v_bfe_u32 v3, v1, 1, 1
v_lshl_add_u32 v30, v3, 4, v30
v_mul_u32_u24 v28, 9216, v31
v_add_u32 v28, v28, v30
v_mul_u32_u24 v29, 1152, v31
v_add_u32 v29, v29, v30
v_lshlrev_b32 v30, 3, v1
v_lshlrev_b32 v31, 2, v31
s_mul_i32 s49, s94, 24
s_mul_i32 s49, s49, 9216
s_mul_i32 s35, s29, 1152
s_add_u32 s49, s49, s35
s_lshl_b32 s35, s48, 7
s_add_u32 s49, s49, s35
s_add_u32 s88, s16, s49
s_addc_u32 s89, s17, 0
s_and_b32 s89, s89, 0xffff
s_mov_b32 s90, 221184
s_mov_b32 s91, 0x20000
s_add_u32 s60, s18, s49
s_addc_u32 s61, s19, 0
s_and_b32 s61, s61, 0xffff
s_mov_b32 s62, 221184
s_mov_b32 s63, 0x20000
s_mul_i32 s49, s29, 576
s_mul_i32 s35, s94, 24
s_add_u32 s49, s49, s35
s_mul_i32 s49, s49, 1152
s_lshl_b32 s35, s48, 7
s_add_u32 s49, s49, s35
s_add_u32 s36, s20, s49
s_addc_u32 s37, s21, 0
s_and_b32 s37, s37, 0xffff
s_mov_b32 s38, 27648
s_mov_b32 s39, 0x20000
s_mov_b32 s57, 73728
s_mov_b32 s58, 147456
L_wm_3:
ds_read_b128 v[40:43], v2 offset:16
s_waitcnt lgkmcnt(0)
v_readfirstlane_b32 s35, v42
s_nop 0
s_cmp_ge_u32 s35, 8
s_cbranch_scc1 L_wmd_4
s_sub_u32 s34, s34, 1
s_cbranch_scc0 L_wm_3
s_branch L_end
L_wmd_4:
v_cndmask_b32 v3, v40, v41, s[50:51]
s_mov_b32 s54, 1040356334
v_mul_f32 v3, s54, v3
v_fma_f32 v16, v16, s54, -v3
v_fma_f32 v17, v17, s54, -v3
v_fma_f32 v18, v18, s54, -v3
v_fma_f32 v19, v19, s54, -v3
v_fma_f32 v20, v20, s54, -v3
v_fma_f32 v21, v21, s54, -v3
v_fma_f32 v22, v22, s54, -v3
v_fma_f32 v23, v23, s54, -v3
v_fma_f32 v24, v24, s54, -v3
v_exp_f32 v16, v16
v_exp_f32 v17, v17
v_exp_f32 v18, v18
v_exp_f32 v19, v19
v_exp_f32 v20, v20
v_exp_f32 v21, v21
v_exp_f32 v22, v22
v_exp_f32 v23, v23
v_exp_f32 v24, v24
s_nop 0
v_add_f32 v4, v16, v17
v_add_f32 v5, v18, v19
v_add_f32 v4, v4, v20
v_add_f32 v5, v5, v21
v_add_f32 v4, v4, v22
v_add_f32 v5, v5, v23
v_add_f32 v4, v4, v24
v_add_f32 v4, v4, v5
s_mov_b64 exec, s[52:53]
ds_add_f32 v8, v4 offset:32
s_mov_b64 exec, -1
v_cvt_pk_bf16_f32 v16, v16, v16
v_cvt_pk_bf16_f32 v17, v17, v17
v_cvt_pk_bf16_f32 v18, v18, v18
v_cvt_pk_bf16_f32 v19, v19, v19
v_cvt_pk_bf16_f32 v20, v20, v20
v_cvt_pk_bf16_f32 v21, v21, v21
v_cvt_pk_bf16_f32 v22, v22, v22
v_cvt_pk_bf16_f32 v23, v23, v23
v_cvt_pk_bf16_f32 v24, v24, v24
v_and_b32 v40, v16, v12
v_and_b32 v41, v16, v13
v_and_b32 v42, v16, v14
v_and_b32 v43, v16, v15
v_and_b32 v44, v17, v12
v_and_b32 v45, v17, v13
v_and_b32 v46, v17, v14
v_and_b32 v47, v17, v15
v_and_b32 v48, v18, v12
v_and_b32 v49, v18, v13
v_and_b32 v50, v18, v14
v_and_b32 v51, v18, v15
v_and_b32 v52, v19, v12
v_and_b32 v53, v19, v13
v_and_b32 v54, v19, v14
v_and_b32 v55, v19, v15
v_and_b32 v56, v20, v12
v_and_b32 v57, v20, v13
v_and_b32 v58, v20, v14
v_and_b32 v59, v20, v15
v_and_b32 v60, v21, v12
v_and_b32 v61, v21, v13
v_and_b32 v62, v21, v14
v_and_b32 v63, v21, v15
v_and_b32 v64, v22, v12
v_and_b32 v65, v22, v13
v_and_b32 v66, v22, v14
v_and_b32 v67, v22, v15
v_and_b32 v68, v23, v12
v_and_b32 v69, v23, v13
v_and_b32 v70, v23, v14
v_and_b32 v71, v23, v15
v_and_b32 v72, v24, v12
v_and_b32 v73, v24, v13
v_and_b32 v74, v24, v14
v_and_b32 v75, v24, v15
s_nop 0
s_waitcnt vmcnt(8)
v_mfma_f32_16x16x32_bf16 v[36:39], v[76:79], v[40:43], 0
s_waitcnt vmcnt(7)
v_mfma_f32_16x16x32_bf16 v[36:39], v[80:83], v[44:47], v[36:39]
s_waitcnt vmcnt(6)
v_mfma_f32_16x16x32_bf16 v[36:39], v[84:87], v[48:51], v[36:39]
s_waitcnt vmcnt(5)
v_mfma_f32_16x16x32_bf16 v[36:39], v[88:91], v[52:55], v[36:39]
s_waitcnt vmcnt(4)
v_mfma_f32_16x16x32_bf16 v[36:39], v[92:95], v[56:59], v[36:39]
s_waitcnt vmcnt(3)
v_mfma_f32_16x16x32_bf16 v[36:39], v[96:99], v[60:63], v[36:39]
s_waitcnt vmcnt(2)
v_mfma_f32_16x16x32_bf16 v[36:39], v[100:103], v[64:67], v[36:39]
s_waitcnt vmcnt(1)
v_mfma_f32_16x16x32_bf16 v[36:39], v[104:107], v[68:71], v[36:39]
s_waitcnt vmcnt(0)
v_mfma_f32_16x16x32_bf16 v[36:39], v[108:111], v[72:75], v[36:39]
s_nop 7
ds_write_b128 v7, v[36:39] offset:4096
s_mov_b64 exec, 1
ds_add_u32 v2, v11 offset:12
s_mov_b64 exec, -1
s_branch L_MM
L_AO:
s_waitcnt lgkmcnt(0)
s_add_u32 s36, s6, s48
s_addc_u32 s37, s7, 0
s_and_b32 s37, s37, 0xffff
s_mov_b32 s38, 33792
s_mov_b32 s39, 0x20000
s_add_u32 s40, s8, s48
s_addc_u32 s41, s9, 0
s_and_b32 s41, s41, 0xffff
s_mov_b32 s42, 33792
s_mov_b32 s43, 0x20000
s_barrier
s_mov_b32 s49, 0
buffer_load_dwordx4 v[40:43], v3, s[36:39], s49 offen nt
s_mov_b32 s49, 8192
buffer_load_dwordx4 v[44:47], v3, s[36:39], s49 offen nt
s_mov_b32 s49, 16384
buffer_load_dwordx4 v[48:51], v3, s[36:39], s49 offen nt
s_waitcnt vmcnt(2)
s_mov_b32 s49, 24576
buffer_load_dwordx4 v[52:55], v3, s[36:39], s49 offen nt
s_waitcnt vmcnt(2)
s_mov_b32 s49, 32768
buffer_load_dwordx4 v[56:59], v3, s[36:39], s49 offen nt
s_waitcnt vmcnt(4)
s_mov_b32 s49, 0
buffer_load_dwordx4 v[76:79], v4, s[40:43], s49 offen nt
s_waitcnt vmcnt(4)
s_mov_b32 s49, 8192
buffer_load_dwordx4 v[80:83], v4, s[40:43], s49 offen nt
s_waitcnt vmcnt(4)
s_mov_b32 s49, 16384
buffer_load_dwordx4 v[84:87], v4, s[40:43], s49 offen nt
s_mov_b64 exec, 1
ds_add_u32 v2, v11 offset:104
s_mov_b64 exec, -1
s_waitcnt vmcnt(4)
s_mov_b32 s49, 24576
buffer_load_dwordx4 v[88:91], v4, s[40:43], s49 offen nt
s_waitcnt vmcnt(4)
s_mov_b32 s49, 32768
buffer_load_dwordx4 v[92:95], v4, s[40:43], s49 offen nt
s_mov_b64 exec, 1
ds_add_u32 v2, v11 offset:8
s_mov_b64 exec, -1
v_bfe_u32 v5, v1, 3, 1
v_cmp_eq_u32 s[50:51], 1, v5
v_lshlrev_b32 v5, 8, v5
v_lshrrev_b32 v6, 4, v1
v_lshl_add_u32 v5, v6, 6, v5
v_and_b32 v6, 3, v1
v_lshl_add_u32 v5, v6, 4, v5
s_lshl_b32 s35, s28, 10
v_lshl_add_u32 v7, v1, 4, s35
v_bfe_u32 v8, v1, 3, 1
v_lshlrev_b32 v8, 2, v8
L_w_5:
ds_read_b32 v3, v2 offset:4
ds_read_b128 v[32:35], v5 offset:2048
ds_read_b32 v10, v2 offset:100
s_waitcnt lgkmcnt(0)
v_readfirstlane_b32 s35, v3
s_nop 0
s_cmp_ge_u32 s35, 1
s_cbranch_scc1 L_wd_6
s_sleep 1
s_sub_u32 s34, s34, 1
s_cbranch_scc0 L_w_5
s_branch L_end
L_wd_6:
s_waitcnt vmcnt(9)
v_mfma_f32_16x16x32_bf16 v[40:43], v[40:43], v[32:35], 0
s_waitcnt vmcnt(8)
v_mfma_f32_16x16x32_bf16 v[44:47], v[44:47], v[32:35], 0
s_waitcnt vmcnt(7)
v_mfma_f32_16x16x32_bf16 v[48:51], v[48:51], v[32:35], 0
s_nop 3
v_mov_b32_dpp v16, v40 quad_perm:[0,0,0,0] row_mask:0xf bank_mask:0xf
v_add_f32_dpp v16, v41, v16 quad_perm:[1,1,1,1] row_mask:0xf bank_mask:0xf
v_add_f32_dpp v16, v42, v16 quad_perm:[2,2,2,2] row_mask:0xf bank_mask:0xf
v_add_f32_dpp v16, v43, v16 quad_perm:[3,3,3,3] row_mask:0xf bank_mask:0xf
s_waitcnt vmcnt(6)
v_mfma_f32_16x16x32_bf16 v[52:55], v[52:55], v[32:35], 0
v_mov_b32_dpp v17, v44 quad_perm:[0,0,0,0] row_mask:0xf bank_mask:0xf
v_add_f32_dpp v17, v45, v17 quad_perm:[1,1,1,1] row_mask:0xf bank_mask:0xf
v_add_f32_dpp v17, v46, v17 quad_perm:[2,2,2,2] row_mask:0xf bank_mask:0xf
v_add_f32_dpp v17, v47, v17 quad_perm:[3,3,3,3] row_mask:0xf bank_mask:0xf
s_waitcnt vmcnt(5)
v_mfma_f32_16x16x32_bf16 v[56:59], v[56:59], v[32:35], 0
v_mov_b32_dpp v18, v48 quad_perm:[0,0,0,0] row_mask:0xf bank_mask:0xf
v_add_f32_dpp v18, v49, v18 quad_perm:[1,1,1,1] row_mask:0xf bank_mask:0xf
v_add_f32_dpp v18, v50, v18 quad_perm:[2,2,2,2] row_mask:0xf bank_mask:0xf
v_add_f32_dpp v18, v51, v18 quad_perm:[3,3,3,3] row_mask:0xf bank_mask:0xf
s_nop 1
v_mov_b32_dpp v19, v52 quad_perm:[0,0,0,0] row_mask:0xf bank_mask:0xf
v_add_f32_dpp v19, v53, v19 quad_perm:[1,1,1,1] row_mask:0xf bank_mask:0xf
v_add_f32_dpp v19, v54, v19 quad_perm:[2,2,2,2] row_mask:0xf bank_mask:0xf
v_add_f32_dpp v19, v55, v19 quad_perm:[3,3,3,3] row_mask:0xf bank_mask:0xf
v_mov_b32_dpp v20, v56 quad_perm:[0,0,0,0] row_mask:0xf bank_mask:0xf
v_add_f32_dpp v20, v57, v20 quad_perm:[1,1,1,1] row_mask:0xf bank_mask:0xf
v_add_f32_dpp v20, v58, v20 quad_perm:[2,2,2,2] row_mask:0xf bank_mask:0xf
v_add_f32_dpp v20, v59, v20 quad_perm:[3,3,3,3] row_mask:0xf bank_mask:0xf
v_max3_f32 v3, v16, v17, v18
v_max3_f32 v3, v3, v19, v20
s_mov_b32 s52, 0x01010101
s_mov_b32 s53, 0x01010101
s_mov_b64 exec, s[52:53]
ds_max_f32 v8, v3 offset:16
s_mov_b64 exec, 1
ds_add_u32 v2, v11 offset:24
s_mov_b64 exec, -1
L_wm_7:
ds_read_b128 v[40:43], v2 offset:16
s_waitcnt lgkmcnt(0)
v_readfirstlane_b32 s35, v42
s_nop 0
s_cmp_ge_u32 s35, 8
s_cbranch_scc1 L_wmd_8
s_sub_u32 s34, s34, 1
s_cbranch_scc0 L_wm_7
s_branch L_end
L_wmd_8:
v_cndmask_b32 v3, v40, v41, s[50:51]
s_mov_b32 s54, 1040356334
v_mul_f32 v3, s54, v3
v_fma_f32 v16, v16, s54, -v3
v_fma_f32 v17, v17, s54, -v3
v_fma_f32 v18, v18, s54, -v3
v_fma_f32 v19, v19, s54, -v3
v_fma_f32 v20, v20, s54, -v3
v_exp_f32 v16, v16
v_exp_f32 v17, v17
v_exp_f32 v18, v18
v_exp_f32 v19, v19
v_exp_f32 v20, v20
s_nop 0
v_add_f32 v4, v16, v17
v_add_f32 v5, v18, v19
v_add_f32 v4, v4, v20
v_add_f32 v4, v4, v5
s_mov_b64 exec, s[52:53]
ds_add_f32 v8, v4 offset:32
s_mov_b64 exec, -1
v_cvt_pk_bf16_f32 v16, v16, v16
v_cvt_pk_bf16_f32 v17, v17, v17
v_cvt_pk_bf16_f32 v18, v18, v18
v_cvt_pk_bf16_f32 v19, v19, v19
v_cvt_pk_bf16_f32 v20, v20, v20
v_and_b32 v40, v16, v12
v_and_b32 v41, v16, v13
v_and_b32 v42, v16, v14
v_and_b32 v43, v16, v15
v_and_b32 v44, v17, v12
v_and_b32 v45, v17, v13
v_and_b32 v46, v17, v14
v_and_b32 v47, v17, v15
v_and_b32 v48, v18, v12
v_and_b32 v49, v18, v13
v_and_b32 v50, v18, v14
v_and_b32 v51, v18, v15
v_and_b32 v52, v19, v12
v_and_b32 v53, v19, v13
v_and_b32 v54, v19, v14
v_and_b32 v55, v19, v15
v_and_b32 v56, v20, v12
v_and_b32 v57, v20, v13
v_and_b32 v58, v20, v14
v_and_b32 v59, v20, v15
s_nop 0
s_waitcnt vmcnt(4)
v_mfma_f32_16x16x32_bf16 v[36:39], v[76:79], v[40:43], 0
s_waitcnt vmcnt(3)
v_mfma_f32_16x16x32_bf16 v[36:39], v[80:83], v[44:47], v[36:39]
s_waitcnt vmcnt(2)
v_mfma_f32_16x16x32_bf16 v[36:39], v[84:87], v[48:51], v[36:39]
s_waitcnt vmcnt(1)
v_mfma_f32_16x16x32_bf16 v[36:39], v[88:91], v[52:55], v[36:39]
s_waitcnt vmcnt(0)
v_mfma_f32_16x16x32_bf16 v[36:39], v[92:95], v[56:59], v[36:39]
s_nop 7
ds_write_b128 v7, v[36:39] offset:4096
s_mov_b64 exec, 1
ds_add_u32 v2, v11 offset:12
s_mov_b64 exec, -1
s_lshl_b32 s48, s93, 1
s_and_b32 s35, s30, 1
s_add_u32 s48, s48, s35
s_mul_i32 s48, s48, 3
s_mul_i32 s35, s29, 24
s_add_u32 s48, s48, s35
s_mul_i32 s49, s48, 9216
s_add_u32 s49, s49, 1945600
s_add_u32 s36, s26, s49
s_addc_u32 s37, s27, 0
s_and_b32 s37, s37, 0xffff
s_mov_b32 s38, 27648
s_mov_b32 s39, 0x20000
s_mul_i32 s49, s48, 4608
s_add_u32 s49, s49, 1060864
s_add_u32 s40, s26, s49
s_addc_u32 s41, s27, 0
s_and_b32 s41, s41, 0xffff
s_mov_b32 s42, 13824
s_mov_b32 s43, 0x20000
s_lshl_b32 s35, s28, 10
v_lshl_add_u32 v3, v1, 4, s35
L_w_9:
ds_read_b32 v4, v2 offset:88
s_waitcnt lgkmcnt(0)
v_readfirstlane_b32 s35, v4
s_nop 0
s_cmp_ge_u32 s35, 1
s_cbranch_scc1 L_wd_10
s_sleep 1
s_sub_u32 s34, s34, 1
s_cbranch_scc0 L_w_9
s_branch L_end
L_wd_10:
s_mov_b32 s49, 0
buffer_load_dwordx4 v[16:19], v3, s[36:39], s49 offen sc1
s_mov_b32 s49, 8192
buffer_load_dwordx4 v[16:19], v3, s[36:39], s49 offen sc1
s_mov_b32 s49, 16384
buffer_load_dwordx4 v[16:19], v3, s[36:39], s49 offen sc1
s_mov_b32 s49, 24576
buffer_load_dwordx4 v[16:19], v3, s[36:39], s49 offen sc1
s_mov_b32 s49, 0
buffer_load_dwordx4 v[16:19], v3, s[40:43], s49 offen sc1
s_mov_b32 s49, 8192
buffer_load_dwordx4 v[16:19], v3, s[40:43], s49 offen sc1
s_waitcnt vmcnt(0)
s_endpgm
L_MM:
s_mov_b32 s44, s26
s_and_b32 s45, s27, 0xffff
s_mov_b32 s46, 16777216
s_mov_b32 s47, 0x20000
L_w_11:
ds_read_b32 v3, v2 offset:68
s_waitcnt lgkmcnt(0)
v_readfirstlane_b32 s35, v3
s_nop 0
s_cmp_ge_u32 s35, 1
s_cbranch_scc1 L_wd_12
s_sleep 1
s_sub_u32 s34, s34, 1
s_cbranch_scc0 L_w_11
s_branch L_end
L_wd_12:
buffer_load_dwordx4 v[40:43], v28, s[88:91], 0 offen nt
buffer_load_dwordx4 v[44:47], v28, s[60:63], 0 offen nt
buffer_load_dwordx4 v[48:51], v28, s[88:91], s57 offen nt
buffer_load_dwordx4 v[52:55], v28, s[60:63], s57 offen nt
buffer_load_dwordx4 v[56:59], v28, s[88:91], s58 offen nt
buffer_load_dwordx4 v[60:63], v28, s[60:63], s58 offen nt
s_movk_i32 s50, 9216
s_movk_i32 s51, 18432
buffer_load_dwordx4 v[64:67], v29, s[36:39], 0 offen nt
buffer_load_dwordx4 v[68:71], v29, s[36:39], s50 offen nt
buffer_load_dwordx4 v[72:75], v29, s[36:39], s51 offen nt
s_mul_i32 s54, s33, 9216
s_lshl_b32 s35, s48, 10
s_add_u32 s54, s54, s35
s_add_u32 s54, s54, 1945600
s_lshl_b32 s35, s48, 9
s_mul_i32 s53, s33, 4608
s_add_u32 s53, s53, s35
s_add_u32 s53, s53, 1060864
v_lshlrev_b32 v8, 4, v1
v_mov_b32 v101, v10
v_mov_b32 v103, v10
v_mov_b32 v109, v10
L_w_13:
ds_read_b32 v3, v2 offset:44
ds_read_b32 v4, v31 offset:3712
ds_read_b32 v5, v31 offset:3744
ds_read_b32 v6, v31 offset:3776
ds_read_b32 v7, v2 offset:52
s_waitcnt lgkmcnt(0)
v_readfirstlane_b32 s35, v3
s_nop 0
s_cmp_ge_u32 s35, 1
s_cbranch_scc1 L_wd_14
s_sub_u32 s34, s34, 1
s_cbranch_scc0 L_w_13
s_branch L_end
L_wd_14:
v_readfirstlane_b32 s98, v7
v_and_b32 v76, v4, v12
v_and_b32 v77, v4, v13
v_and_b32 v78, v4, v14
v_and_b32 v79, v4, v15
v_and_b32 v80, v5, v12
v_and_b32 v81, v5, v13
v_and_b32 v82, v5, v14
v_and_b32 v83, v5, v15
v_and_b32 v84, v6, v12
v_and_b32 v85, v6, v13
v_and_b32 v86, v6, v14
v_and_b32 v87, v6, v15
s_waitcnt vmcnt(7)
v_mfma_f32_16x16x32_bf16 v[88:91], v[40:43], v[76:79], 0
v_mfma_f32_16x16x32_bf16 v[92:95], v[44:47], v[76:79], 0
s_waitcnt vmcnt(5)
v_mfma_f32_16x16x32_bf16 v[88:91], v[48:51], v[80:83], v[88:91]
v_mfma_f32_16x16x32_bf16 v[92:95], v[52:55], v[80:83], v[92:95]
s_waitcnt vmcnt(3)
v_mfma_f32_16x16x32_bf16 v[88:91], v[56:59], v[84:87], v[88:91]
v_mfma_f32_16x16x32_bf16 v[92:95], v[60:63], v[84:87], v[92:95]
s_nop 6
v_permlane32_swap_b32 v88, v89
v_permlane32_swap_b32 v90, v91
v_permlane32_swap_b32 v92, v93
v_permlane32_swap_b32 v94, v95
v_add_f32_dpp v100, v89, v88 row_ror:8 row_mask:0xf bank_mask:0x3
v_add_f32_dpp v100, v90, v91 row_ror:8 row_mask:0xf bank_mask:0xc
v_add_f32_dpp v102, v93, v92 row_ror:8 row_mask:0xf bank_mask:0x3
v_add_f32_dpp v102, v94, v95 row_ror:8 row_mask:0xf bank_mask:0xc
s_cmp_eq_u32 s98, 0
s_cbranch_scc1 L_slow_15
buffer_store_dwordx4 v[100:103], v8, s[44:47], s54 offen nt
s_branch L_pd_16
L_slow_15:
buffer_store_dwordx4 v[100:103], v8, s[44:47], s54 offen sc1
L_pd_16:
s_mov_b64 exec, 1
ds_add_u32 v2, v11 offset:92
s_mov_b64 exec, -1
L_w_17:
ds_read_b32 v3, v2 offset:48
ds_read_b32 v4, v31 offset:3840
ds_read_b32 v5, v31 offset:3872
ds_read_b32 v6, v31 offset:3904
s_waitcnt lgkmcnt(0)
v_readfirstlane_b32 s35, v3
s_nop 0
s_cmp_ge_u32 s35, 1
s_cbranch_scc1 L_wd_18
s_sub_u32 s34, s34, 1
s_cbranch_scc0 L_w_17
s_branch L_end
L_wd_18:
v_and_b32 v76, v4, v12
v_and_b32 v77, v4, v13
v_and_b32 v78, v4, v14
v_and_b32 v79, v4, v15
v_and_b32 v80, v5, v12
v_and_b32 v81, v5, v13
v_and_b32 v82, v5, v14
v_and_b32 v83, v5, v15
v_and_b32 v84, v6, v12
v_and_b32 v85, v6, v13
v_and_b32 v86, v6, v14
v_and_b32 v87, v6, v15
s_waitcnt vmcnt(1)
s_nop 0
v_mfma_f32_16x16x32_bf16 v[104:107], v[64:67], v[76:79], 0
v_mfma_f32_16x16x32_bf16 v[104:107], v[68:71], v[80:83], v[104:107]
v_mfma_f32_16x16x32_bf16 v[104:107], v[72:75], v[84:87], v[104:107]
s_nop 7
v_permlane32_swap_b32 v104, v105
v_permlane32_swap_b32 v106, v107
s_nop 1
v_add_f32_dpp v108, v105, v104 row_ror:8 row_mask:0xf bank_mask:0x3
v_add_f32_dpp v108, v106, v107 row_ror:8 row_mask:0xf bank_mask:0xc
s_cmp_eq_u32 s98, 0
s_cbranch_scc1 L_slow_19
buffer_store_dwordx2 v[108:109], v30, s[44:47], s53 offen nt
s_branch L_pd_20
L_slow_19:
buffer_store_dwordx2 v[108:109], v30, s[44:47], s53 offen sc1
L_pd_20:
s_mov_b64 exec, 1
ds_add_u32 v2, v11 offset:96
s_mov_b64 exec, -1
s_endpgm
L_H:
s_waitcnt lgkmcnt(0)
s_barrier
s_mov_b32 s48, 8
s_cmp_eq_u32 s92, 0
s_cbranch_scc1 L_hO_21
v_lshrrev_b32 v31, 4, v1
v_lshlrev_b32 v31, 1, v31
v_bfe_u32 v3, v1, 3, 1
v_add_u32 v31, v31, v3
v_and_b32 v30, 1, v1
v_lshlrev_b32 v30, 6, v30
v_bfe_u32 v3, v1, 2, 1
v_lshl_add_u32 v30, v3, 5, v30
v_bfe_u32 v3, v1, 1, 1
v_lshl_add_u32 v30, v3, 4, v30
v_mul_u32_u24 v28, 9216, v31
v_add_u32 v28, v28, v30
v_mul_u32_u24 v29, 1152, v31
v_add_u32 v29, v29, v30
v_lshlrev_b32 v30, 3, v1
v_lshlrev_b32 v31, 2, v31
s_mul_i32 s49, s94, 24
s_mul_i32 s49, s49, 9216
s_mul_i32 s35, s29, 1152
s_add_u32 s49, s49, s35
s_lshl_b32 s35, s48, 7
s_add_u32 s49, s49, s35
s_add_u32 s88, s16, s49
s_addc_u32 s89, s17, 0
s_and_b32 s89, s89, 0xffff
s_mov_b32 s90, 221184
s_mov_b32 s91, 0x20000
s_add_u32 s60, s18, s49
s_addc_u32 s61, s19, 0
s_and_b32 s61, s61, 0xffff
s_mov_b32 s62, 221184
s_mov_b32 s63, 0x20000
s_mul_i32 s49, s29, 576
s_mul_i32 s35, s94, 24
s_add_u32 s49, s49, s35
s_mul_i32 s49, s49, 1152
s_lshl_b32 s35, s48, 7
s_add_u32 s49, s49, s35
s_add_u32 s36, s20, s49
s_addc_u32 s37, s21, 0
s_and_b32 s37, s37, 0xffff
s_mov_b32 s38, 27648
s_mov_b32 s39, 0x20000
s_mov_b32 s57, 73728
s_mov_b32 s58, 147456
L_w_22:
ds_read_b32 v4, v2 offset:4
ds_read_b32 v10, v2 offset:100
s_waitcnt lgkmcnt(0)
v_readfirstlane_b32 s35, v4
s_nop 0
s_cmp_ge_u32 s35, 1
s_cbranch_scc1 L_wd_23
s_sleep 1
s_sub_u32 s34, s34, 1
s_cbranch_scc0 L_w_22
s_branch L_end
L_wd_23:
s_branch L_MM
L_hO_21:
v_lshrrev_b32 v8, 4, v1
v_lshlrev_b32 v8, 1, v8
v_bfe_u32 v3, v1, 3, 1
v_add_u32 v8, v8, v3
v_and_b32 v9, 1, v1
v_lshlrev_b32 v9, 6, v9
v_bfe_u32 v3, v1, 2, 1
v_lshl_add_u32 v9, v3, 5, v9
v_bfe_u32 v3, v1, 1, 1
v_lshl_add_u32 v9, v3, 4, v9
s_branch L_WO1
L_W:
s_setprio 2
s_sub_u32 s48, s28, 8
s_and_b32 s49, s32, 3
s_lshr_b32 s50, s32, 2
s_mul_i32 s51, s50, 144
s_mul_i32 s35, s48, 24
s_add_u32 s51, s51, s35
s_lshl_b32 s52, s51, 13
s_lshl_b32 s35, s31, 9
s_add_u32 s52, s52, s35
s_lshl_b32 s35, s49, 7
s_add_u32 s52, s52, s35
v_lshrrev_b32 v8, 4, v1
v_lshlrev_b32 v8, 1, v8
v_bfe_u32 v3, v1, 3, 1
v_add_u32 v8, v8, v3
v_and_b32 v9, 1, v1
v_lshlrev_b32 v9, 6, v9
v_bfe_u32 v3, v1, 2, 1
v_lshl_add_u32 v9, v3, 5, v9
v_bfe_u32 v3, v1, 1, 1
v_lshl_add_u32 v9, v3, 4, v9
v_lshl_add_u32 v5, v8, 13, v9
s_mov_b32 s54, 0x10000
s_mov_b32 s55, 0x20000
s_waitcnt lgkmcnt(0)
s_add_u32 s36, s10, s52
s_addc_u32 s37, s11, 0
s_and_b32 s37, s37, 0xffff
s_mov_b32 s38, 196608
s_mov_b32 s39, 0x20000
buffer_load_dwordx4 v[32:35], v5, s[36:39], 0 offen nt
buffer_load_dwordx4 v[36:39], v5, s[36:39], s54 offen nt
buffer_load_dwordx4 v[40:43], v5, s[36:39], s55 offen nt
s_barrier
s_setprio 0
v_mov_b32 v7, v1
s_lshl_b32 s53, s51, 1
v_lshl_add_u32 v4, v8, 1, s53
L_w_24:
ds_read_b32 v3, v2 offset:64
ds_read_u16 v24, v4 offset:12288
ds_read_u16 v25, v4 offset:12304
ds_read_u16 v26, v4 offset:12320
ds_read_b64 v[28:29], v2 offset:56
s_waitcnt lgkmcnt(0)
v_readfirstlane_b32 s35, v3
s_nop 0
s_cmp_ge_u32 s35, 1
s_cbranch_scc1 L_wd_25
s_sub_u32 s34, s34, 1
s_cbranch_scc0 L_w_24
s_branch L_end
L_wd_25:
v_lshlrev_b32 v24, 16, v24
v_sub_f32 v24, v24, v28
v_lshlrev_b32 v25, 16, v25
v_sub_f32 v25, v25, v28
v_lshlrev_b32 v26, 16, v26
v_sub_f32 v26, v26, v28
v_mul_f32 v24, v24, v29
v_mul_f32 v25, v25, v29
v_mul_f32 v26, v26, v29
v_cvt_pk_bf16_f32 v24, v24, v24
v_cvt_pk_bf16_f32 v25, v25, v25
v_cvt_pk_bf16_f32 v26, v26, v26
v_and_b32 v44, v24, v12
v_and_b32 v45, v24, v13
v_and_b32 v46, v24, v14
v_and_b32 v47, v24, v15
v_and_b32 v48, v25, v12
v_and_b32 v49, v25, v13
v_and_b32 v50, v25, v14
v_and_b32 v51, v25, v15
v_and_b32 v52, v26, v12
v_and_b32 v53, v26, v13
v_and_b32 v54, v26, v14
v_and_b32 v55, v26, v15
s_nop 0
s_waitcnt vmcnt(2)
v_mfma_f32_16x16x32_bf16 v[56:59], v[32:35], v[44:47], 0
s_waitcnt vmcnt(1)
v_mfma_f32_16x16x32_bf16 v[56:59], v[36:39], v[48:51], v[56:59]
s_waitcnt vmcnt(0)
v_mfma_f32_16x16x32_bf16 v[56:59], v[40:43], v[52:55], v[56:59]
s_lshl_b32 s35, s48, 8
v_lshl_add_u32 v3, v7, 2, s35
s_nop 5
v_permlane32_swap_b32 v56, v57
v_permlane32_swap_b32 v58, v59
s_nop 1
v_add_f32_dpp v60, v57, v56 row_ror:8 row_mask:0xf bank_mask:0x3
v_add_f32_dpp v60, v58, v59 row_ror:8 row_mask:0xf bank_mask:0xc
ds_write_b32 v3, v60 offset:256
s_mov_b64 exec, 1
ds_add_u32 v2, v11 offset:0
s_mov_b64 exec, -1
s_cmp_eq_u32 s92, 0
s_cbranch_scc1 L_WOsel
s_cmp_eq_u32 s48, 3
s_cbranch_scc0 L_Wexit
L_Wexit:
s_endpgm
L_WOsel:
s_cmp_eq_u32 s48, 5
s_cbranch_scc0 L_nopre_26
s_mov_b32 s44, s26
s_and_b32 s45, s27, 0xffff
s_mov_b32 s46, 16777216
s_mov_b32 s47, 0x20000
v_lshlrev_b32 v3, 4, v1
L_w_27:
ds_read_b32 v4, v2 offset:80
s_waitcnt lgkmcnt(0)
v_readfirstlane_b32 s35, v4
s_nop 0
s_cmp_ge_u32 s35, 1
s_cbranch_scc1 L_wd_28
s_sleep 1
s_sub_u32 s34, s34, 1
s_cbranch_scc0 L_w_27
s_branch L_end
L_wd_28:
s_lshl_b32 s48, s31, 2
s_add_u32 s48, s48, s93
s_lshl_b32 s48, s48, 13
s_add_u32 s48, s48, 135168
buffer_load_dwordx4 v[16:19], v3, s[44:47], s48 offen sc1
s_add_u32 s48, s48, 1024
buffer_load_dwordx4 v[16:19], v3, s[44:47], s48 offen sc1
s_add_u32 s48, s48, 1024
buffer_load_dwordx4 v[16:19], v3, s[44:47], s48 offen sc1
s_add_u32 s48, s48, 1024
buffer_load_dwordx4 v[16:19], v3, s[44:47], s48 offen sc1
s_add_u32 s48, s48, 1024
buffer_load_dwordx4 v[16:19], v3, s[44:47], s48 offen sc1
s_add_u32 s48, s48, 1024
buffer_load_dwordx4 v[16:19], v3, s[44:47], s48 offen sc1
s_add_u32 s48, s48, 1024
buffer_load_dwordx4 v[16:19], v3, s[44:47], s48 offen sc1
s_add_u32 s48, s48, 1024
buffer_load_dwordx4 v[16:19], v3, s[44:47], s48 offen sc1
s_lshl_b32 s48, s31, 9
s_add_u32 s48, s48, 659456
s_mov_b32 exec_hi, 0
buffer_load_dwordx4 v[16:19], v3, s[44:47], s48 offen sc1
s_lshl_b32 s48, s29, 9
s_add_u32 s48, s48, 3716096
buffer_load_dwordx4 v[16:19], v3, s[44:47], s48 offen sc1
s_mov_b64 exec, -1
s_lshl_b32 s48, s93, 1
s_and_b32 s35, s30, 1
s_add_u32 s48, s48, s35
s_lshl_b32 s35, s29, 3
s_add_u32 s48, s48, s35
s_mul_i32 s48, s48, 4736
s_add_u32 s48, s48, 716800
buffer_load_dwordx4 v[16:19], v3, s[44:47], s48 offen sc1
s_add_u32 s48, s48, 1024
buffer_load_dwordx4 v[16:19], v3, s[44:47], s48 offen sc1
s_add_u32 s48, s48, 1024
buffer_load_dwordx4 v[16:19], v3, s[44:47], s48 offen sc1
s_add_u32 s48, s48, 1024
buffer_load_dwordx4 v[16:19], v3, s[44:47], s48 offen sc1
s_add_u32 s48, s48, 1024
s_mov_b32 exec_hi, 0xff
buffer_load_dwordx4 v[16:19], v3, s[44:47], s48 offen sc1
s_mov_b64 exec, -1
s_mov_b32 s48, 5
L_nopre_26:
s_cmp_lt_u32 s48, 2
s_cbranch_scc0 L_one_29
s_lshl_b32 s48, s48, 1
s_branch L_WO2
L_one_29:
s_add_u32 s48, s48, 2
s_branch L_WO1
L_WO1:
s_mov_b32 s44, s26
s_and_b32 s45, s27, 0xffff
s_mov_b32 s46, 16777216
s_mov_b32 s47, 0x20000
s_lshl_b32 s49, s31, 8
s_lshl_b32 s35, s93, 6
s_add_u32 s49, s49, s35
s_mul_i32 s49, s49, 1152
s_lshl_b32 s35, s48, 7
s_add_u32 s49, s49, s35
s_add_u32 s36, s12, s49
s_addc_u32 s37, s13, 0
s_and_b32 s37, s37, 0xffff
s_mov_b32 s38, 73728
s_mov_b32 s39, 0x20000
v_mul_u32_u24 v4, 1152, v8
v_add_u32 v4, v4, v9
v_lshlrev_b32 v27, 2, v8
v_lshlrev_b32 v26, 3, v1
L_w_30:
ds_read_b32 v3, v2 offset:80
ds_read_b32 v10, v2 offset:100
s_waitcnt lgkmcnt(0)
v_readfirstlane_b32 s35, v3
s_nop 0
s_cmp_ge_u32 s35, 1
s_cbranch_scc1 L_wd_31
s_sleep 1
s_sub_u32 s34, s34, 1
s_cbranch_scc0 L_w_30
s_branch L_end
L_wd_31:
s_mov_b32 s49, 0
buffer_load_dwordx4 v[32:35], v4, s[36:39], s49 offen offset:0 nt
s_mov_b32 s49, 9216
buffer_load_dwordx4 v[36:39], v4, s[36:39], s49 offen offset:0 nt
s_mov_b32 s49, 18432
buffer_load_dwordx4 v[40:43], v4, s[36:39], s49 offen offset:0 nt
s_mov_b32 s49, 27648
buffer_load_dwordx4 v[44:47], v4, s[36:39], s49 offen offset:0 nt
s_mov_b32 s49, 36864
buffer_load_dwordx4 v[48:51], v4, s[36:39], s49 offen offset:0 nt
s_mov_b32 s49, 46080
buffer_load_dwordx4 v[52:55], v4, s[36:39], s49 offen offset:0 nt
s_mov_b32 s49, 55296
buffer_load_dwordx4 v[56:59], v4, s[36:39], s49 offen offset:0 nt
s_mov_b32 s49, 64512
buffer_load_dwordx4 v[60:63], v4, s[36:39], s49 offen offset:0 nt
s_lshl_b32 s53, s93, 1
s_and_b32 s35, s30, 1
s_add_u32 s53, s53, s35
s_lshl_b32 s35, s29, 3
s_add_u32 s53, s53, s35
s_mul_i32 s53, s53, 4736
s_add_u32 s53, s53, 716800
s_lshl_b32 s35, s48, 9
s_add_u32 s54, s53, s35
s_add_u32 s53, s53, 4608
v_and_b32 v9, 7, v1
v_lshlrev_b32 v9, 4, v9
v_mov_b32 v5, v10
v_mov_b32 v7, v10
L_w_32:
ds_read_b32 v3, v2 offset:12
s_waitcnt lgkmcnt(0)
v_readfirstlane_b32 s35, v3
s_nop 0
s_cmp_ge_u32 s35, 8
s_cbranch_scc1 L_wd_33
s_sleep 1
s_sub_u32 s34, s34, 1
s_cbranch_scc0 L_w_32
s_branch L_end
L_wd_33:
L_w_34:
ds_read_b32 v3, v2 offset:40
ds_read_b32 v96, v27 offset:3328
ds_read_b32 v100, v27 offset:3360
ds_read_b32 v104, v27 offset:3392
ds_read_b32 v108, v27 offset:3424
ds_read_b32 v112, v27 offset:3456
ds_read_b32 v116, v27 offset:3488
ds_read_b32 v120, v27 offset:3520
ds_read_b32 v124, v27 offset:3552
ds_read_b32 v24, v2 offset:52
s_waitcnt lgkmcnt(0)
v_readfirstlane_b32 s35, v3
s_nop 0
s_cmp_ge_u32 s35, 1
s_cbranch_scc1 L_wd_35
s_sub_u32 s34, s34, 1
s_cbranch_scc0 L_w_34
s_branch L_end
L_wd_35:
v_readfirstlane_b32 s98, v24
v_and_b32 v99, v96, v15
v_and_b32 v98, v96, v14
v_and_b32 v97, v96, v13
v_and_b32 v96, v96, v12
v_and_b32 v103, v100, v15
v_and_b32 v102, v100, v14
v_and_b32 v101, v100, v13
v_and_b32 v100, v100, v12
v_and_b32 v107, v104, v15
v_and_b32 v106, v104, v14
v_and_b32 v105, v104, v13
v_and_b32 v104, v104, v12
v_and_b32 v111, v108, v15
v_and_b32 v110, v108, v14
v_and_b32 v109, v108, v13
v_and_b32 v108, v108, v12
v_and_b32 v115, v112, v15
v_and_b32 v114, v112, v14
v_and_b32 v113, v112, v13
v_and_b32 v112, v112, v12
v_and_b32 v119, v116, v15
v_and_b32 v118, v116, v14
v_and_b32 v117, v116, v13
v_and_b32 v116, v116, v12
v_and_b32 v123, v120, v15
v_and_b32 v122, v120, v14
v_and_b32 v121, v120, v13
v_and_b32 v120, v120, v12
v_and_b32 v127, v124, v15
v_and_b32 v126, v124, v14
v_and_b32 v125, v124, v13
v_and_b32 v124, v124, v12
s_waitcnt vmcnt(7)
v_mfma_f32_16x16x32_bf16 v[16:19], v[32:35], v[96:99], 0
s_waitcnt vmcnt(6)
v_mfma_f32_16x16x32_bf16 v[16:19], v[36:39], v[100:103], v[16:19]
s_waitcnt vmcnt(5)
v_mfma_f32_16x16x32_bf16 v[16:19], v[40:43], v[104:107], v[16:19]
s_waitcnt vmcnt(4)
v_mfma_f32_16x16x32_bf16 v[16:19], v[44:47], v[108:111], v[16:19]
s_waitcnt vmcnt(3)
v_mfma_f32_16x16x32_bf16 v[16:19], v[48:51], v[112:115], v[16:19]
s_waitcnt vmcnt(2)
v_mfma_f32_16x16x32_bf16 v[16:19], v[52:55], v[116:119], v[16:19]
s_waitcnt vmcnt(1)
v_mfma_f32_16x16x32_bf16 v[16:19], v[56:59], v[120:123], v[16:19]
s_waitcnt vmcnt(0)
v_mfma_f32_16x16x32_bf16 v[16:19], v[60:63], v[124:127], v[16:19]
s_nop 7
v_permlane32_swap_b32 v16, v17
v_permlane32_swap_b32 v18, v19
s_nop 1
v_add_f32_dpp v4, v17, v16 row_ror:8 row_mask:0xf bank_mask:0x3
v_add_f32_dpp v4, v18, v19 row_ror:8 row_mask:0xf bank_mask:0xc
s_cmp_eq_u32 s98, 0
s_cbranch_scc1 L_slow_36
buffer_store_dwordx2 v[4:5], v26, s[44:47], s54 offen offset:0 nt
s_branch L_pd_37
L_slow_36:
buffer_store_dwordx2 v[4:5], v26, s[44:47], s54 offen offset:0 sc1
L_pd_37:
v_mov_b32 v28, v4
s_nop 1
v_add_f32_dpp v28, v28, v28 row_ror:8 row_mask:0xf bank_mask:0xf
s_nop 1
v_add_f32_dpp v28, v28, v28 row_ror:4 row_mask:0xf bank_mask:0xf
s_nop 1
v_add_f32_dpp v28, v28, v28 row_ror:2 row_mask:0xf bank_mask:0xf
s_nop 1
v_add_f32_dpp v28, v28, v28 row_ror:1 row_mask:0xf bank_mask:0xf
s_nop 1
v_add_f32_dpp v28, v28, v28 row_bcast:15 row_mask:0xa bank_mask:0xf
s_nop 1
v_add_f32_dpp v28, v28, v28 row_bcast:31 row_mask:0xc bank_mask:0xf
s_nop 1
v_mov_b32 v29, v10
v_mov_b32 v31, v10
s_mov_b32 s50, 0
s_mov_b32 s51, 0x80000000
s_mov_b64 exec, s[50:51]
ds_add_f32 v2, v28 offset:72
ds_add_rtn_u32 v3, v2, v11 offset:76
s_waitcnt lgkmcnt(0)
v_readfirstlane_b32 s35, v3
s_mov_b64 exec, -1
s_cmp_eq_u32 s35, 6
s_cbranch_scc0 L_tdone_38
ds_read_b32 v28, v2 offset:72
s_waitcnt lgkmcnt(0)
v_mov_b32 v30, v28
s_mov_b64 exec, 0xff
s_cmp_eq_u32 s98, 0
s_cbranch_scc1 L_slow_39
buffer_store_dwordx4 v[28:31], v9, s[44:47], s53 offen nt
s_branch L_pd_40
L_slow_39:
buffer_store_dwordx4 v[28:31], v9, s[44:47], s53 offen sc1
L_pd_40:
s_mov_b64 exec, -1
s_mov_b64 exec, 1
ds_write_b32 v2, v11 offset:84
s_mov_b64 exec, -1
L_tdone_38:
s_endpgm
L_WO2:
s_mov_b32 s44, s26
s_and_b32 s45, s27, 0xffff
s_mov_b32 s46, 16777216
s_mov_b32 s47, 0x20000
s_lshl_b32 s49, s31, 8
s_lshl_b32 s35, s93, 6
s_add_u32 s49, s49, s35
s_mul_i32 s49, s49, 1152
s_lshl_b32 s35, s48, 7
s_add_u32 s49, s49, s35
s_add_u32 s36, s12, s49
s_addc_u32 s37, s13, 0
s_and_b32 s37, s37, 0xffff
s_mov_b32 s38, 73728
s_mov_b32 s39, 0x20000
v_mul_u32_u24 v4, 1152, v8
v_add_u32 v4, v4, v9
v_lshlrev_b32 v27, 2, v8
v_lshlrev_b32 v26, 3, v1
L_w_41:
ds_read_b32 v3, v2 offset:80
ds_read_b32 v10, v2 offset:100
s_waitcnt lgkmcnt(0)
v_readfirstlane_b32 s35, v3
s_nop 0
s_cmp_ge_u32 s35, 1
s_cbranch_scc1 L_wd_42
s_sleep 1
s_sub_u32 s34, s34, 1
s_cbranch_scc0 L_w_41
s_branch L_end
L_wd_42:
s_mov_b32 s49, 0
buffer_load_dwordx4 v[32:35], v4, s[36:39], s49 offen offset:0 nt
buffer_load_dwordx4 v[64:67], v4, s[36:39], s49 offen offset:128 nt
s_mov_b32 s49, 9216
buffer_load_dwordx4 v[36:39], v4, s[36:39], s49 offen offset:0 nt
buffer_load_dwordx4 v[68:71], v4, s[36:39], s49 offen offset:128 nt
s_mov_b32 s49, 18432
buffer_load_dwordx4 v[40:43], v4, s[36:39], s49 offen offset:0 nt
buffer_load_dwordx4 v[72:75], v4, s[36:39], s49 offen offset:128 nt
s_mov_b32 s49, 27648
buffer_load_dwordx4 v[44:47], v4, s[36:39], s49 offen offset:0 nt
buffer_load_dwordx4 v[76:79], v4, s[36:39], s49 offen offset:128 nt
s_mov_b32 s49, 36864
buffer_load_dwordx4 v[48:51], v4, s[36:39], s49 offen offset:0 nt
buffer_load_dwordx4 v[80:83], v4, s[36:39], s49 offen offset:128 nt
s_mov_b32 s49, 46080
buffer_load_dwordx4 v[52:55], v4, s[36:39], s49 offen offset:0 nt
buffer_load_dwordx4 v[84:87], v4, s[36:39], s49 offen offset:128 nt
s_mov_b32 s49, 55296
buffer_load_dwordx4 v[56:59], v4, s[36:39], s49 offen offset:0 nt
buffer_load_dwordx4 v[88:91], v4, s[36:39], s49 offen offset:128 nt
s_mov_b32 s49, 64512
buffer_load_dwordx4 v[60:63], v4, s[36:39], s49 offen offset:0 nt
buffer_load_dwordx4 v[92:95], v4, s[36:39], s49 offen offset:128 nt
s_lshl_b32 s53, s93, 1
s_and_b32 s35, s30, 1
s_add_u32 s53, s53, s35
s_lshl_b32 s35, s29, 3
s_add_u32 s53, s53, s35
s_mul_i32 s53, s53, 4736
s_add_u32 s53, s53, 716800
s_lshl_b32 s35, s48, 9
s_add_u32 s54, s53, s35
s_add_u32 s53, s53, 4608
v_and_b32 v9, 7, v1
v_lshlrev_b32 v9, 4, v9
v_mov_b32 v5, v10
v_mov_b32 v7, v10
L_w_43:
ds_read_b32 v3, v2 offset:12
s_waitcnt lgkmcnt(0)
v_readfirstlane_b32 s35, v3
s_nop 0
s_cmp_ge_u32 s35, 8
s_cbranch_scc1 L_wd_44
s_sleep 1
s_sub_u32 s34, s34, 1
s_cbranch_scc0 L_w_43
s_branch L_end
L_wd_44:
L_w_45:
ds_read_b32 v3, v2 offset:40
ds_read_b32 v96, v27 offset:3328
ds_read_b32 v100, v27 offset:3360
ds_read_b32 v104, v27 offset:3392
ds_read_b32 v108, v27 offset:3424
ds_read_b32 v112, v27 offset:3456
ds_read_b32 v116, v27 offset:3488
ds_read_b32 v120, v27 offset:3520
ds_read_b32 v124, v27 offset:3552
ds_read_b32 v24, v2 offset:52
s_waitcnt lgkmcnt(0)
v_readfirstlane_b32 s35, v3
s_nop 0
s_cmp_ge_u32 s35, 1
s_cbranch_scc1 L_wd_46
s_sub_u32 s34, s34, 1
s_cbranch_scc0 L_w_45
s_branch L_end
L_wd_46:
v_readfirstlane_b32 s98, v24
v_and_b32 v99, v96, v15
v_and_b32 v98, v96, v14
v_and_b32 v97, v96, v13
v_and_b32 v96, v96, v12
v_and_b32 v103, v100, v15
v_and_b32 v102, v100, v14
v_and_b32 v101, v100, v13
v_and_b32 v100, v100, v12
v_and_b32 v107, v104, v15
v_and_b32 v106, v104, v14
v_and_b32 v105, v104, v13
v_and_b32 v104, v104, v12
v_and_b32 v111, v108, v15
v_and_b32 v110, v108, v14
v_and_b32 v109, v108, v13
v_and_b32 v108, v108, v12
v_and_b32 v115, v112, v15
v_and_b32 v114, v112, v14
v_and_b32 v113, v112, v13
v_and_b32 v112, v112, v12
v_and_b32 v119, v116, v15
v_and_b32 v118, v116, v14
v_and_b32 v117, v116, v13
v_and_b32 v116, v116, v12
v_and_b32 v123, v120, v15
v_and_b32 v122, v120, v14
v_and_b32 v121, v120, v13
v_and_b32 v120, v120, v12
v_and_b32 v127, v124, v15
v_and_b32 v126, v124, v14
v_and_b32 v125, v124, v13
v_and_b32 v124, v124, v12
s_waitcnt vmcnt(14)
v_mfma_f32_16x16x32_bf16 v[16:19], v[32:35], v[96:99], 0
v_mfma_f32_16x16x32_bf16 v[20:23], v[64:67], v[96:99], 0
s_waitcnt vmcnt(12)
v_mfma_f32_16x16x32_bf16 v[16:19], v[36:39], v[100:103], v[16:19]
v_mfma_f32_16x16x32_bf16 v[20:23], v[68:71], v[100:103], v[20:23]
s_waitcnt vmcnt(10)
v_mfma_f32_16x16x32_bf16 v[16:19], v[40:43], v[104:107], v[16:19]
v_mfma_f32_16x16x32_bf16 v[20:23], v[72:75], v[104:107], v[20:23]
s_waitcnt vmcnt(8)
v_mfma_f32_16x16x32_bf16 v[16:19], v[44:47], v[108:111], v[16:19]
v_mfma_f32_16x16x32_bf16 v[20:23], v[76:79], v[108:111], v[20:23]
s_waitcnt vmcnt(6)
v_mfma_f32_16x16x32_bf16 v[16:19], v[48:51], v[112:115], v[16:19]
v_mfma_f32_16x16x32_bf16 v[20:23], v[80:83], v[112:115], v[20:23]
s_waitcnt vmcnt(4)
v_mfma_f32_16x16x32_bf16 v[16:19], v[52:55], v[116:119], v[16:19]
v_mfma_f32_16x16x32_bf16 v[20:23], v[84:87], v[116:119], v[20:23]
s_waitcnt vmcnt(2)
v_mfma_f32_16x16x32_bf16 v[16:19], v[56:59], v[120:123], v[16:19]
v_mfma_f32_16x16x32_bf16 v[20:23], v[88:91], v[120:123], v[20:23]
s_waitcnt vmcnt(0)
v_mfma_f32_16x16x32_bf16 v[16:19], v[60:63], v[124:127], v[16:19]
v_mfma_f32_16x16x32_bf16 v[20:23], v[92:95], v[124:127], v[20:23]
s_nop 6
v_permlane32_swap_b32 v16, v17
v_permlane32_swap_b32 v18, v19
v_permlane32_swap_b32 v20, v21
v_permlane32_swap_b32 v22, v23
v_add_f32_dpp v4, v17, v16 row_ror:8 row_mask:0xf bank_mask:0x3
v_add_f32_dpp v4, v18, v19 row_ror:8 row_mask:0xf bank_mask:0xc
v_add_f32_dpp v6, v21, v20 row_ror:8 row_mask:0xf bank_mask:0x3
v_add_f32_dpp v6, v22, v23 row_ror:8 row_mask:0xf bank_mask:0xc
s_cmp_eq_u32 s98, 0
s_cbranch_scc1 L_slow_47
buffer_store_dwordx2 v[4:5], v26, s[44:47], s54 offen offset:0 nt
buffer_store_dwordx2 v[6:7], v26, s[44:47], s54 offen offset:512 nt
s_branch L_pd_48
L_slow_47:
buffer_store_dwordx2 v[4:5], v26, s[44:47], s54 offen offset:0 sc1
buffer_store_dwordx2 v[6:7], v26, s[44:47], s54 offen offset:512 sc1
L_pd_48:
v_add_f32 v28, v4, v6
s_nop 1
v_add_f32_dpp v28, v28, v28 row_ror:8 row_mask:0xf bank_mask:0xf
s_nop 1
v_add_f32_dpp v28, v28, v28 row_ror:4 row_mask:0xf bank_mask:0xf
s_nop 1
v_add_f32_dpp v28, v28, v28 row_ror:2 row_mask:0xf bank_mask:0xf
s_nop 1
v_add_f32_dpp v28, v28, v28 row_ror:1 row_mask:0xf bank_mask:0xf
s_nop 1
v_add_f32_dpp v28, v28, v28 row_bcast:15 row_mask:0xa bank_mask:0xf
s_nop 1
v_add_f32_dpp v28, v28, v28 row_bcast:31 row_mask:0xc bank_mask:0xf
s_nop 1
v_mov_b32 v29, v10
v_mov_b32 v31, v10
s_mov_b32 s50, 0
s_mov_b32 s51, 0x80000000
s_mov_b64 exec, s[50:51]
ds_add_f32 v2, v28 offset:72
ds_add_rtn_u32 v3, v2, v11 offset:76
s_waitcnt lgkmcnt(0)
v_readfirstlane_b32 s35, v3
s_mov_b64 exec, -1
s_cmp_eq_u32 s35, 6
s_cbranch_scc0 L_tdone_49
ds_read_b32 v28, v2 offset:72
s_waitcnt lgkmcnt(0)
v_mov_b32 v30, v28
s_mov_b64 exec, 0xff
s_cmp_eq_u32 s98, 0
s_cbranch_scc1 L_slow_50
buffer_store_dwordx4 v[28:31], v9, s[44:47], s53 offen nt
s_branch L_pd_51
L_slow_50:
buffer_store_dwordx4 v[28:31], v9, s[44:47], s53 offen sc1
L_pd_51:
s_mov_b64 exec, -1
s_mov_b64 exec, 1
ds_write_b32 v2, v11 offset:84
s_mov_b64 exec, -1
L_tdone_49:
s_endpgm
L_C:
s_setprio 3
v_lshlrev_b32 v3, 4, v1
s_waitcnt lgkmcnt(0)
s_load_dword s56, s[26:27], 0
s_mov_b32 s40, s4
s_and_b32 s41, s5, 0xffff
s_mov_b32 s42, 1152
s_mov_b32 s43, 0x20000
buffer_load_dwordx4 v[16:19], v3, s[40:43], 0 offen
buffer_load_dwordx4 v[20:23], v3, s[40:43], 0 offen offset:1024
v_and_b32 v9, 15, v1
v_lshlrev_b32 v4, 2, v9
s_mul_i32 s48, s94, 48
v_add_u32 v8, s48, v4
v_mov_b32 v5, 2146435072
v_cmp_gt_u32 vcc, 12, v9
s_nop 1
v_cndmask_b32 v4, v5, v8, vcc
s_cmp_eq_u32 s92, 0
s_cselect_b32 s42, 0, s42
buffer_load_dword v24, v4, s[40:43], 0 offen
s_barrier
s_mov_b32 s44, s26
s_and_b32 s45, s27, 0xffff
s_mov_b32 s46, 16777216
s_mov_b32 s47, 0x20000
s_mov_b32 s36, s22
s_and_b32 s37, s23, 0xffff
s_mov_b32 s38, 1152
s_mov_b32 s39, 0x20000
v_mov_b32 v6, 0x3f803f80
v_mov_b32 v32, 0
v_mov_b32 v33, 0
s_waitcnt vmcnt(1)
ds_write_b128 v3, v[16:19] offset:12288
s_mov_b64 exec, 0xff
ds_write_b128 v3, v[20:23] offset:13312
s_mov_b64 exec, -1
v_dot2_f32_bf16 v32, v16, v6, v32
v_dot2_f32_bf16 v33, v16, v16, v33
v_dot2_f32_bf16 v32, v17, v6, v32
v_dot2_f32_bf16 v33, v17, v17, v33
v_dot2_f32_bf16 v32, v18, v6, v32
v_dot2_f32_bf16 v33, v18, v18, v33
v_dot2_f32_bf16 v32, v19, v6, v32
v_dot2_f32_bf16 v33, v19, v19, v33
v_dot2_f32_bf16 v32, v20, v6, v32
v_dot2_f32_bf16 v33, v20, v20, v33
v_dot2_f32_bf16 v32, v21, v6, v32
v_dot2_f32_bf16 v33, v21, v21, v33
v_dot2_f32_bf16 v32, v22, v6, v32
v_dot2_f32_bf16 v33, v22, v22, v33
v_dot2_f32_bf16 v32, v23, v6, v32
v_dot2_f32_bf16 v33, v23, v23, v33
s_nop 2
s_nop 1
v_add_f32_dpp v32, v32, v32 row_ror:8 row_mask:0xf bank_mask:0xf
v_add_f32_dpp v33, v33, v33 row_ror:8 row_mask:0xf bank_mask:0xf
s_nop 0
v_add_f32_dpp v32, v32, v32 row_ror:4 row_mask:0xf bank_mask:0xf
v_add_f32_dpp v33, v33, v33 row_ror:4 row_mask:0xf bank_mask:0xf
s_nop 0
v_add_f32_dpp v32, v32, v32 row_ror:2 row_mask:0xf bank_mask:0xf
v_add_f32_dpp v33, v33, v33 row_ror:2 row_mask:0xf bank_mask:0xf
s_nop 0
v_add_f32_dpp v32, v32, v32 row_ror:1 row_mask:0xf bank_mask:0xf
v_add_f32_dpp v33, v33, v33 row_ror:1 row_mask:0xf bank_mask:0xf
s_nop 0
v_add_f32_dpp v32, v32, v32 row_bcast:15 row_mask:0xa bank_mask:0xf
v_add_f32_dpp v33, v33, v33 row_bcast:15 row_mask:0xa bank_mask:0xf
s_nop 0
v_add_f32_dpp v32, v32, v32 row_bcast:31 row_mask:0xc bank_mask:0xf
v_add_f32_dpp v33, v33, v33 row_bcast:31 row_mask:0xc bank_mask:0xf
s_nop 0
v_readlane_b32 s57, v32, 63
v_readlane_b32 s58, v33, 63
v_mov_b32 v30, 987991609
s_nop 0
v_mul_f32 v32, s57, v30
v_mul_f32 v33, s58, v30
v_fma_f32 v33, -v32, v32, v33
v_add_f32 v33, 925353388, v33
v_rsq_f32 v33, v33
s_nop 0
s_mov_b64 exec, 1
ds_write_b64 v2, v[32:33] offset:56
ds_write_b32 v2, v11 offset:64
s_mov_b64 exec, -1
v_lshrrev_b32 v5, 4, v1
v_lshlrev_b32 v6, 4, v9
v_mov_b32 v37, v6
s_mul_i32 s49, s94, 192
v_add_u32 v7, s49, v6
v_cmp_gt_u32 vcc, 12, v9
s_mul_i32 s49, s94, 0x5556
s_lshr_b32 s49, s49, 16
s_mul_i32 s35, s49, 3
s_sub_u32 s35, s94, s35
s_mul_i32 s35, s35, 192
s_mul_i32 s95, s49, 640
s_add_u32 s95, s95, 1019904
v_add_u32 v25, s35, v6
v_mov_b32 v4, 576
v_cndmask_b32 v25, v4, v25, vcc
v_mul_u32_u24 v4, 5120, v5
v_add_u32 v25, v25, v4
v_mul_u32_u24 v26, 4608, v5
v_add_u32 v26, v26, v7
v_mul_u32_u24 v27, 6144, v5
v_add_u32 v27, v27, v6
v_and_b32 v38, 31, v1
s_mul_i32 s49, s94, 24
v_add_u32 v4, s49, v38
v_lshlrev_b32 v4, 4, v4
v_lshrrev_b32 v28, 5, v1
v_mul_u32_u24 v44, 9216, v28
v_add_u32 v4, v4, v44
v_lshlrev_b32 v28, 4, v28
s_mul_i32 s49, s29, 4294746624
s_add_u32 s49, s49, 1770496
v_add_u32 v28, s49, v28
v_cmp_gt_u32 vcc, 24, v38
s_nop 1
v_cndmask_b32 v28, v28, v4, vcc
v_mov_b32 v4, 4294948896
v_cndmask_b32 v44, v4, v2, vcc
v_lshrrev_b32 v29, 5, v1
v_lshlrev_b32 v29, 11, v29
v_and_b32 v4, 31, v1
v_lshl_add_u32 v29, v4, 4, v29
v_bfe_u32 v30, v1, 3, 1
v_lshlrev_b32 v30, 14, v30
v_bfe_u32 v4, v1, 5, 1
v_lshl_add_u32 v30, v4, 13, v30
v_bfe_u32 v4, v1, 4, 1
v_lshl_add_u32 v30, v4, 7, v30
v_and_b32 v4, 7, v1
v_lshl_add_u32 v30, v4, 4, v30
v_lshlrev_b32 v31, 4, v1
s_mov_b32 s58, 536813567
s_mov_b32 s59, 536813567
s_mov_b32 s60, 268374015
s_mov_b32 s61, 268374015
s_mov_b32 s62, 33554431
s_mov_b32 s63, 33554431
s_waitcnt vmcnt(0) lgkmcnt(0)
s_add_u32 s56, s56, 1
v_mov_b32 v10, s56
s_mov_b64 exec, 1
ds_write_b32 v2, v10 offset:100
s_mov_b64 exec, -1
v_lshlrev_b32 v16, 16, v24
v_and_b32 v17, 0xffff0000, v24
s_getreg_b32 s99, hwreg(HW_REG_XCC_ID, 0, 4)
v_mov_b32 v22, s99
v_mov_b32 v23, v10
s_lshl_b32 s97, s29, 8
s_add_u32 s97, s97, 2048
s_lshl_b32 s96, s30, 3
s_add_u32 s96, s96, s97
v_and_b32 v40, 31, v1
v_lshlrev_b32 v40, 3, v40
s_and_b32 s48, s32, 3
s_lshr_b32 s49, s32, 2
s_lshl_b32 s50, s31, 13
s_add_u32 s50, s50, 4096
s_lshl_b32 s35, s48, 11
s_add_u32 s51, s50, s35
s_lshl_b32 s35, s49, 9
s_add_u32 s51, s51, s35
v_lshlrev_b32 v3, 2, v1
v_lshlrev_b32 v5, 3, v1
L_w_52:
ds_read_b32 v4, v2 offset:0
ds_read_b32 v48, v3 offset:256
ds_read_b32 v49, v3 offset:512
ds_read_b32 v50, v3 offset:768
ds_read_b32 v51, v3 offset:1024
ds_read_b32 v52, v3 offset:1280
ds_read_b32 v53, v3 offset:1536
s_waitcnt lgkmcnt(0)
v_readfirstlane_b32 s35, v4
s_nop 0
s_cmp_ge_u32 s35, 6
s_cbranch_scc1 L_wd_53
s_sub_u32 s34, s34, 1
s_cbranch_scc0 L_w_52
s_branch L_end
L_wd_53:
v_add_f32 v48, v48, v49
v_add_f32 v50, v50, v51
v_add_f32 v52, v52, v53
v_add_f32 v48, v48, v50
v_add_f32 v48, v48, v52
v_mov_b32 v49, v10
buffer_store_dwordx2 v[48:49], v5, s[44:47], s51 offen sc1
s_mov_b64 exec, 1
buffer_store_dwordx2 v[22:23], v2, s[44:47], s96 offen sc1
s_mov_b64 exec, -1
s_mov_b64 exec, 1
ds_write_b32 v2, v11 offset:80
s_mov_b64 exec, -1
s_add_u32 s51, s50, 4096
L_w_54:
ds_read_b32 v4, v2 offset:104
s_waitcnt lgkmcnt(0)
v_readfirstlane_b32 s35, v4
s_nop 0
s_cmp_ge_u32 s35, 8
s_cbranch_scc1 L_wd_55
s_sleep 1
s_sub_u32 s34, s34, 1
s_cbranch_scc0 L_w_54
s_branch L_end
L_wd_55:
L_h1_56:
buffer_load_dwordx4 v[48:51], v29, s[44:47], s50 offen offset:0 sc1
buffer_load_dwordx4 v[52:55], v29, s[44:47], s50 offen offset:512 sc1
buffer_load_dwordx4 v[56:59], v29, s[44:47], s50 offen offset:1024 sc1
buffer_load_dwordx4 v[60:63], v29, s[44:47], s50 offen offset:1536 sc1
buffer_load_dwordx4 v[64:67], v29, s[44:47], s51 offen offset:0 sc1
buffer_load_dwordx4 v[68:71], v29, s[44:47], s51 offen offset:512 sc1
buffer_load_dwordx4 v[72:75], v29, s[44:47], s51 offen offset:1024 sc1
buffer_load_dwordx4 v[76:79], v29, s[44:47], s51 offen offset:1536 sc1
buffer_load_dwordx2 v[46:47], v40, s[44:47], s97 offen sc1
s_waitcnt vmcnt(0)
v_xor_b32 v4, v49, v10
v_bitop3_b32 v4, v4, v51, v10 bitop3:0xf6
v_bitop3_b32 v4, v4, v53, v10 bitop3:0xf6
v_bitop3_b32 v4, v4, v55, v10 bitop3:0xf6
v_bitop3_b32 v4, v4, v57, v10 bitop3:0xf6
v_bitop3_b32 v4, v4, v59, v10 bitop3:0xf6
v_bitop3_b32 v4, v4, v61, v10 bitop3:0xf6
v_bitop3_b32 v4, v4, v63, v10 bitop3:0xf6
v_bitop3_b32 v4, v4, v65, v10 bitop3:0xf6
v_bitop3_b32 v4, v4, v67, v10 bitop3:0xf6
v_bitop3_b32 v4, v4, v69, v10 bitop3:0xf6
v_bitop3_b32 v4, v4, v71, v10 bitop3:0xf6
v_bitop3_b32 v4, v4, v73, v10 bitop3:0xf6
v_bitop3_b32 v4, v4, v75, v10 bitop3:0xf6
v_bitop3_b32 v4, v4, v77, v10 bitop3:0xf6
v_bitop3_b32 v4, v4, v79, v10 bitop3:0xf6
v_bitop3_b32 v4, v4, v47, v10 bitop3:0xf6
v_cmp_ne_u32 vcc, 0, v4
s_cbranch_vccz L_ok_57
s_sub_u32 s34, s34, 1
s_cbranch_scc0 L_h1_56
s_branch L_end
L_ok_57:
v_add_f32 v48, v48, v52
v_add_f32 v56, v56, v60
v_add_f32 v50, v50, v54
v_add_f32 v58, v58, v62
v_add_f32 v48, v48, v56
v_add_f32 v50, v50, v58
v_cvt_pk_bf16_f32 v48, v48, v50
ds_write_b32 v3, v48 offset:2048
v_add_f32 v64, v64, v68
v_add_f32 v72, v72, v76
v_add_f32 v66, v66, v70
v_add_f32 v74, v74, v78
v_add_f32 v64, v64, v72
v_add_f32 v66, v66, v74
v_cvt_pk_bf16_f32 v64, v64, v66
ds_write_b32 v3, v64 offset:2304
s_mov_b64 exec, 1
ds_write_b32 v2, v11 offset:4
s_mov_b64 exec, -1
v_cmp_ne_u32 vcc, s99, v46
s_mov_b32 s98, 1
s_cbranch_vccz L_isfast
s_mov_b32 s98, 0
L_isfast:
v_mov_b32 v4, s98
s_mov_b64 exec, 1
ds_write_b32 v2, v4 offset:52
s_mov_b64 exec, -1
s_lshl_b32 s48, s31, 15
s_add_u32 s48, s48, 135168
s_lshl_b32 s35, s32, 9
s_add_u32 s49, s48, s35
s_lshl_b32 s35, s93, 13
s_add_u32 s51, s48, s35
s_lshl_b32 s52, s31, 9
s_add_u32 s52, s52, 659456
s_lshr_b32 s35, s93, 1
s_lshl_b32 s35, s35, 8
s_add_u32 s53, s52, s35
s_lshl_b32 s35, s32, 4
s_add_u32 s52, s52, s35
v_lshlrev_b32 v33, 8, v1
v_lshlrev_b32 v34, 2, v1
v_mov_b32 v113, v10
v_mov_b32 v115, v10
v_mov_b32 v117, v10
v_mov_b32 v119, v10
v_mov_b32 v121, v10
v_mov_b32 v123, v10
s_mov_b32 s54, 1040356334
L_w_58:
ds_read_b32 v3, v2 offset:12
s_waitcnt lgkmcnt(0)
v_readfirstlane_b32 s35, v3
s_nop 0
s_cmp_ge_u32 s35, 7
s_cbranch_scc1 L_wd_59
s_sleep 1
s_sub_u32 s34, s34, 1
s_cbranch_scc0 L_w_58
s_branch L_end
L_wd_59:
L_w_60:
ds_read_b32 v4, v2 offset:12
ds_read_b128 v[48:51], v31 offset:4096
ds_read_b128 v[52:55], v31 offset:5120
ds_read_b128 v[56:59], v31 offset:6144
ds_read_b128 v[60:63], v31 offset:7168
ds_read_b128 v[64:67], v31 offset:8192
ds_read_b128 v[68:71], v31 offset:9216
ds_read_b128 v[72:75], v31 offset:10240
ds_read_b128 v[76:79], v31 offset:11264
ds_read_b32 v80, v34 offset:16
ds_read_b32 v81, v34 offset:32
s_waitcnt lgkmcnt(0)
v_readfirstlane_b32 s35, v4
s_nop 0
s_cmp_ge_u32 s35, 8
s_cbranch_scc1 L_wd_61
s_sub_u32 s34, s34, 1
s_cbranch_scc0 L_w_60
s_branch L_end
L_wd_61:
v_add_f32 v48, v48, v52
v_add_f32 v49, v49, v53
v_add_f32 v50, v50, v54
v_add_f32 v51, v51, v55
v_add_f32 v56, v56, v60
v_add_f32 v57, v57, v61
v_add_f32 v58, v58, v62
v_add_f32 v59, v59, v63
v_add_f32 v64, v64, v68
v_add_f32 v65, v65, v69
v_add_f32 v66, v66, v70
v_add_f32 v67, v67, v71
v_add_f32 v72, v72, v76
v_add_f32 v73, v73, v77
v_add_f32 v74, v74, v78
v_add_f32 v75, v75, v79
v_add_f32 v48, v48, v56
v_add_f32 v49, v49, v57
v_add_f32 v50, v50, v58
v_add_f32 v51, v51, v59
v_add_f32 v64, v64, v72
v_add_f32 v65, v65, v73
v_add_f32 v66, v66, v74
v_add_f32 v67, v67, v75
v_add_f32 v112, v48, v64
v_add_f32 v114, v49, v65
v_add_f32 v116, v50, v66
v_add_f32 v118, v51, v67
v_mul_f32 v120, s54, v80
v_mov_b32 v122, v81
s_cmp_eq_u32 s98, 0
s_cbranch_scc1 L_slow_62
buffer_store_dwordx4 v[112:115], v30, s[44:47], s49 offen nt
buffer_store_dwordx4 v[116:119], v30, s[44:47], s49 offen offset:256 nt
s_mov_b64 exec, 3
buffer_store_dwordx4 v[120:123], v33, s[44:47], s52 offen nt
s_mov_b64 exec, -1
s_branch L_pd_63
L_slow_62:
buffer_store_dwordx4 v[112:115], v30, s[44:47], s49 offen sc1
buffer_store_dwordx4 v[116:119], v30, s[44:47], s49 offen offset:256 sc1
s_mov_b64 exec, 3
buffer_store_dwordx4 v[120:123], v33, s[44:47], s52 offen sc1
s_mov_b64 exec, -1
L_pd_63:
s_mov_b64 exec, 1
ds_write_b32 v2, v11 offset:68
s_mov_b64 exec, -1
s_cmp_eq_u32 s92, 0
s_cbranch_scc0 L_CM
v_lshrrev_b32 v36, 5, v1
v_lshlrev_b32 v36, 4, v36
v_and_b32 v41, 7, v1
v_bfe_u32 v7, v1, 3, 1
v_lshl_add_u32 v41, v7, 5, v41
v_bfe_u32 v7, v1, 4, 1
v_lshl_add_u32 v41, v7, 4, v41
v_lshlrev_b32 v41, 2, v41
s_add_u32 s50, s51, 4096
L_h2_64:
buffer_load_dwordx4 v[48:51], v31, s[44:47], s51 offen offset:0 sc1
buffer_load_dwordx4 v[52:55], v31, s[44:47], s51 offen offset:1024 sc1
buffer_load_dwordx4 v[56:59], v31, s[44:47], s51 offen offset:2048 sc1
buffer_load_dwordx4 v[60:63], v31, s[44:47], s51 offen offset:3072 sc1
buffer_load_dwordx4 v[64:67], v31, s[44:47], s50 offen offset:0 sc1
buffer_load_dwordx4 v[68:71], v31, s[44:47], s50 offen offset:1024 sc1
buffer_load_dwordx4 v[72:75], v31, s[44:47], s50 offen offset:2048 sc1
buffer_load_dwordx4 v[76:79], v31, s[44:47], s50 offen offset:3072 sc1
buffer_load_dwordx4 v[80:83], v36, s[44:47], s53 offen offset:0 sc1
buffer_load_dwordx4 v[84:87], v36, s[44:47], s53 offen offset:32 sc1
buffer_load_dwordx4 v[88:91], v36, s[44:47], s53 offen offset:64 sc1
buffer_load_dwordx4 v[92:95], v36, s[44:47], s53 offen offset:96 sc1
buffer_load_dwordx4 v[96:99], v36, s[44:47], s53 offen offset:128 sc1
buffer_load_dwordx4 v[100:103], v36, s[44:47], s53 offen offset:160 sc1
buffer_load_dwordx4 v[104:107], v36, s[44:47], s53 offen offset:192 sc1
buffer_load_dwordx4 v[108:111], v36, s[44:47], s53 offen offset:224 sc1
s_waitcnt vmcnt(0)
v_xor_b32 v4, v49, v10
v_bitop3_b32 v4, v4, v51, v10 bitop3:0xf6
v_bitop3_b32 v4, v4, v53, v10 bitop3:0xf6
v_bitop3_b32 v4, v4, v55, v10 bitop3:0xf6
v_bitop3_b32 v4, v4, v57, v10 bitop3:0xf6
v_bitop3_b32 v4, v4, v59, v10 bitop3:0xf6
v_bitop3_b32 v4, v4, v61, v10 bitop3:0xf6
v_bitop3_b32 v4, v4, v63, v10 bitop3:0xf6
v_bitop3_b32 v4, v4, v65, v10 bitop3:0xf6
v_bitop3_b32 v4, v4, v67, v10 bitop3:0xf6
v_bitop3_b32 v4, v4, v69, v10 bitop3:0xf6
v_bitop3_b32 v4, v4, v71, v10 bitop3:0xf6
v_bitop3_b32 v4, v4, v73, v10 bitop3:0xf6
v_bitop3_b32 v4, v4, v75, v10 bitop3:0xf6
v_bitop3_b32 v4, v4, v77, v10 bitop3:0xf6
v_bitop3_b32 v4, v4, v79, v10 bitop3:0xf6
v_bitop3_b32 v4, v4, v81, v10 bitop3:0xf6
v_bitop3_b32 v4, v4, v83, v10 bitop3:0xf6
v_bitop3_b32 v4, v4, v85, v10 bitop3:0xf6
v_bitop3_b32 v4, v4, v87, v10 bitop3:0xf6
v_bitop3_b32 v4, v4, v89, v10 bitop3:0xf6
v_bitop3_b32 v4, v4, v91, v10 bitop3:0xf6
v_bitop3_b32 v4, v4, v93, v10 bitop3:0xf6
v_bitop3_b32 v4, v4, v95, v10 bitop3:0xf6
v_bitop3_b32 v4, v4, v97, v10 bitop3:0xf6
v_bitop3_b32 v4, v4, v99, v10 bitop3:0xf6
v_bitop3_b32 v4, v4, v101, v10 bitop3:0xf6
v_bitop3_b32 v4, v4, v103, v10 bitop3:0xf6
v_bitop3_b32 v4, v4, v105, v10 bitop3:0xf6
v_bitop3_b32 v4, v4, v107, v10 bitop3:0xf6
v_bitop3_b32 v4, v4, v109, v10 bitop3:0xf6
v_bitop3_b32 v4, v4, v111, v10 bitop3:0xf6
v_cmp_ne_u32 vcc, 0, v4
s_cbranch_vccz L_ok_65
s_sub_u32 s34, s34, 1
s_cbranch_scc0 L_h2_64
s_branch L_end
L_ok_65:
v_max3_f32 v4, v80, v84, v88
v_max3_f32 v5, v92, v96, v100
v_max3_f32 v4, v4, v104, v108
v_max_f32 v4, v4, v5
v_mov_b32 v5, v4
s_nop 1
v_permlane32_swap_b32 v4, v5
s_nop 0
v_max_f32 v4, v4, v5
v_sub_f32 v80, v80, v4
v_sub_f32 v84, v84, v4
v_sub_f32 v88, v88, v4
v_sub_f32 v92, v92, v4
v_sub_f32 v96, v96, v4
v_sub_f32 v100, v100, v4
v_sub_f32 v104, v104, v4
v_sub_f32 v108, v108, v4
v_exp_f32 v80, v80
v_exp_f32 v84, v84
v_exp_f32 v88, v88
v_exp_f32 v92, v92
v_exp_f32 v96, v96
v_exp_f32 v100, v100
v_exp_f32 v104, v104
v_exp_f32 v108, v108
s_nop 0
v_mul_f32 v4, v80, v82
v_mul_f32 v5, v80, v48
v_mul_f32 v6, v80, v50
v_fmac_f32 v4, v84, v86
v_fmac_f32 v5, v84, v52
v_fmac_f32 v6, v84, v54
v_fmac_f32 v4, v88, v90
v_fmac_f32 v5, v88, v56
v_fmac_f32 v6, v88, v58
v_fmac_f32 v4, v92, v94
v_fmac_f32 v5, v92, v60
v_fmac_f32 v6, v92, v62
v_fmac_f32 v4, v96, v98
v_fmac_f32 v5, v96, v64
v_fmac_f32 v6, v96, v66
v_fmac_f32 v4, v100, v102
v_fmac_f32 v5, v100, v68
v_fmac_f32 v6, v100, v70
v_fmac_f32 v4, v104, v106
v_fmac_f32 v5, v104, v72
v_fmac_f32 v6, v104, v74
v_fmac_f32 v4, v108, v110
v_fmac_f32 v5, v108, v76
v_fmac_f32 v6, v108, v78
v_mov_b32 v7, v4
v_mov_b32 v20, v5
v_mov_b32 v21, v6
s_nop 0
v_permlane32_swap_b32 v4, v7
v_permlane32_swap_b32 v5, v20
v_permlane32_swap_b32 v6, v21
s_nop 0
v_add_f32 v4, v4, v7
v_add_f32 v5, v5, v20
v_add_f32 v6, v6, v21
v_rcp_f32 v4, v4
s_nop 0
v_mul_f32 v5, v5, v4
v_mul_f32 v6, v6, v4
v_cvt_pk_bf16_f32 v5, v5, v5
v_cvt_pk_bf16_f32 v6, v6, v6
s_mov_b32 exec_hi, 0
ds_write_b32 v41, v5 offset:3328
ds_write_b32 v41, v6 offset:3360
s_mov_b64 exec, 1
ds_write_b32 v2, v11 offset:40
s_mov_b64 exec, -1
s_lshl_b32 s48, s93, 1
s_and_b32 s35, s30, 1
s_add_u32 s48, s48, s35
s_mul_i32 s49, s48, 576
v_lshlrev_b32 v20, 4, v1
v_add_u32 v20, s49, v20
v_mov_b32 v4, 4608
v_cmp_gt_u32 vcc, 36, v1
s_nop 1
v_cndmask_b32 v20, v4, v20, vcc
s_mul_i32 s51, s29, 37888
s_add_u32 s51, s51, 716800
s_lshl_b32 s35, s29, 3
s_add_u32 s49, s35, s48
s_mul_i32 s49, s49, 640
s_add_u32 s49, s49, 1019904
L_w_66:
ds_read_b32 v4, v2 offset:84
s_waitcnt lgkmcnt(0)
v_readfirstlane_b32 s35, v4
s_nop 0
s_cmp_ge_u32 s35, 1
s_cbranch_scc1 L_wd_67
s_sub_u32 s34, s34, 1
s_cbranch_scc0 L_w_66
s_branch L_end
L_wd_67:
s_mov_b32 exec_lo, -1
s_mov_b32 exec_hi, 0x1f
L_h3a_68:
s_mov_b32 s50, s51
buffer_load_dwordx4 v[48:51], v20, s[44:47], s50 offen sc1
s_add_u32 s50, s50, 4736
buffer_load_dwordx4 v[52:55], v20, s[44:47], s50 offen sc1
s_add_u32 s50, s50, 4736
buffer_load_dwordx4 v[56:59], v20, s[44:47], s50 offen sc1
s_add_u32 s50, s50, 4736
buffer_load_dwordx4 v[60:63], v20, s[44:47], s50 offen sc1
s_add_u32 s50, s50, 4736
buffer_load_dwordx4 v[64:67], v20, s[44:47], s50 offen sc1
s_add_u32 s50, s50, 4736
buffer_load_dwordx4 v[68:71], v20, s[44:47], s50 offen sc1
s_add_u32 s50, s50, 4736
buffer_load_dwordx4 v[72:75], v20, s[44:47], s50 offen sc1
s_add_u32 s50, s50, 4736
buffer_load_dwordx4 v[76:79], v20, s[44:47], s50 offen sc1
s_waitcnt vmcnt(0)
v_xor_b32 v4, v49, v10
v_bitop3_b32 v4, v4, v51, v10 bitop3:0xf6
v_bitop3_b32 v4, v4, v53, v10 bitop3:0xf6
v_bitop3_b32 v4, v4, v55, v10 bitop3:0xf6
v_bitop3_b32 v4, v4, v57, v10 bitop3:0xf6
v_bitop3_b32 v4, v4, v59, v10 bitop3:0xf6
v_bitop3_b32 v4, v4, v61, v10 bitop3:0xf6
v_bitop3_b32 v4, v4, v63, v10 bitop3:0xf6
v_bitop3_b32 v4, v4, v65, v10 bitop3:0xf6
v_bitop3_b32 v4, v4, v67, v10 bitop3:0xf6
v_bitop3_b32 v4, v4, v69, v10 bitop3:0xf6
v_bitop3_b32 v4, v4, v71, v10 bitop3:0xf6
v_bitop3_b32 v4, v4, v73, v10 bitop3:0xf6
v_bitop3_b32 v4, v4, v75, v10 bitop3:0xf6
v_bitop3_b32 v4, v4, v77, v10 bitop3:0xf6
v_bitop3_b32 v4, v4, v79, v10 bitop3:0xf6
v_cmp_ne_u32 vcc, 0, v4
s_cbranch_vccz L_ok_69
s_sub_u32 s34, s34, 1
s_cbranch_scc0 L_h3a_68
s_branch L_end
L_ok_69:
v_add_f32 v48, v48, v52
v_add_f32 v50, v50, v54
v_add_f32 v56, v56, v60
v_add_f32 v58, v58, v62
v_add_f32 v64, v64, v68
v_add_f32 v66, v66, v70
v_add_f32 v72, v72, v76
v_add_f32 v74, v74, v78
v_add_f32 v48, v48, v56
v_add_f32 v50, v50, v58
v_add_f32 v64, v64, v72
v_add_f32 v66, v66, v74
v_add_f32 v48, v48, v64
v_add_f32 v50, v50, v66
s_mov_b32 exec_hi, 0xff
v_mov_b32 v49, v10
v_mov_b32 v51, v10
buffer_store_dwordx4 v[48:51], v31, s[44:47], s49 offen sc1
s_mov_b64 exec, -1
s_mov_b64 exec, 1
ds_write_b32 v2, v11 offset:88
s_mov_b64 exec, -1
s_endpgm
L_CM:
s_mov_b64 exec, s[58:59]
L_h3_70:
s_mov_b32 s50, s95
buffer_load_dwordx4 v[48:51], v25, s[44:47], s50 offen sc1
s_add_u32 s50, s50, 20480
buffer_load_dwordx4 v[52:55], v25, s[44:47], s50 offen sc1
s_waitcnt vmcnt(0)
v_xor_b32 v4, v49, v10
v_bitop3_b32 v4, v4, v51, v10 bitop3:0xf6
v_bitop3_b32 v4, v4, v53, v10 bitop3:0xf6
v_bitop3_b32 v4, v4, v55, v10 bitop3:0xf6
v_cmp_ne_u32 vcc, 0, v4
s_cbranch_vccz L_ok_71
s_sub_u32 s34, s34, 1
s_cbranch_scc0 L_h3_70
s_branch L_end
L_ok_71:
v_add_f32 v48, v48, v52
v_add_f32 v50, v50, v54
s_mov_b64 exec, -1
v_mov_b32 v6, v48
v_mov_b32 v7, v50
s_nop 0
v_permlane16_swap_b32 v48, v6
v_permlane16_swap_b32 v50, v7
s_nop 0
v_add_f32 v48, v48, v6
v_add_f32 v50, v50, v7
v_mov_b32 v6, v48
v_mov_b32 v7, v50
s_nop 0
v_permlane32_swap_b32 v48, v6
v_permlane32_swap_b32 v50, v7
s_nop 0
v_add_f32 v48, v48, v6
v_add_f32 v50, v50, v7
v_readlane_b32 s50, v48, 12
v_cvt_pk_bf16_f32 v4, v48, v50
v_mov_b32 v5, s57
v_lshlrev_b32 v6, 16, v4
v_and_b32 v7, 0xffff0000, v4
v_add_f32 v5, s50, v5
v_add_f32 v6, v6, v16
v_add_f32 v7, v7, v17
v_cvt_pk_bf16_f32 v4, v6, v7
v_mul_f32 v5, 987991609, v5
v_lshlrev_b32 v18, 16, v4
v_and_b32 v19, 0xffff0000, v4
v_sub_f32 v6, v18, v5
v_sub_f32 v7, v19, v5
v_cvt_pk_bf16_f32 v20, v6, v6
v_cvt_pk_bf16_f32 v21, v7, v7
v_lshlrev_b32 v4, 3, v9
s_mov_b64 exec, 0xfff
ds_write_b64 v4, v[20:21] offset:3712
s_mov_b64 exec, 1
ds_write_b32 v2, v11 offset:44
s_mov_b64 exec, -1
s_cmp_eq_u32 s33, 0
s_cbranch_scc0 L_noep_72
s_mov_b64 exec, 1
buffer_store_dword v10, v2, s[44:47], 0 offen sc1
s_mov_b64 exec, -1
L_noep_72:
v_mul_f32 v6, v6, v6
v_fmac_f32 v6, v7, v7
v_cmp_gt_u32 vcc, 12, v9
s_nop 1
v_cndmask_b32 v6, 0, v6, vcc
s_nop 1
v_add_f32_dpp v6, v6, v6 row_ror:8 row_mask:0xf bank_mask:0xf
s_nop 1
v_add_f32_dpp v6, v6, v6 row_ror:4 row_mask:0xf bank_mask:0xf
s_nop 1
v_add_f32_dpp v6, v6, v6 row_ror:2 row_mask:0xf bank_mask:0xf
s_nop 1
v_add_f32_dpp v6, v6, v6 row_ror:1 row_mask:0xf bank_mask:0xf
s_nop 1
v_mov_b32 v20, v6
v_mov_b32 v21, v10
v_mov_b32 v22, v6
v_mov_b32 v23, v10
s_lshl_b32 s48, s29, 9
s_lshl_b32 s35, s94, 4
s_add_u32 s48, s48, s35
s_add_u32 s48, s48, 3716096
s_mov_b64 exec, 1
s_cmp_eq_u32 s98, 0
s_cbranch_scc1 L_slow_73
buffer_store_dwordx4 v[20:23], v2, s[44:47], s48 offen nt
s_branch L_pd_74
L_slow_73:
buffer_store_dwordx4 v[20:23], v2, s[44:47], s48 offen sc1
L_pd_74:
s_mov_b64 exec, -1
s_mul_i32 s48, s29, 221184
s_add_u32 s48, s48, 1945600
L_w_75:
ds_read_b32 v4, v2 offset:92
s_waitcnt lgkmcnt(0)
v_readfirstlane_b32 s35, v4
s_nop 0
s_cmp_ge_u32 s35, 9
s_cbranch_scc1 L_wd_76
s_sub_u32 s34, s34, 1
s_cbranch_scc0 L_w_75
s_branch L_end
L_wd_76:
s_mov_b64 exec, s[62:63]
L_h3c_77:
s_mov_b32 s50, s48
v_mov_b32 v45, v28
buffer_load_dwordx4 v[48:51], v45, s[44:47], s50 offen sc1
s_add_u32 s50, s50, 18432
v_add_u32 v45, v45, v44
buffer_load_dwordx4 v[52:55], v45, s[44:47], s50 offen sc1
s_add_u32 s50, s50, 18432
v_add_u32 v45, v45, v44
buffer_load_dwordx4 v[56:59], v45, s[44:47], s50 offen sc1
s_add_u32 s50, s50, 18432
v_add_u32 v45, v45, v44
buffer_load_dwordx4 v[60:63], v45, s[44:47], s50 offen sc1
s_add_u32 s50, s50, 18432
v_add_u32 v45, v45, v44
buffer_load_dwordx4 v[64:67], v45, s[44:47], s50 offen sc1
s_add_u32 s50, s50, 18432
v_add_u32 v45, v45, v44
buffer_load_dwordx4 v[68:71], v45, s[44:47], s50 offen sc1
s_add_u32 s50, s50, 18432
v_add_u32 v45, v45, v44
buffer_load_dwordx4 v[72:75], v45, s[44:47], s50 offen sc1
s_add_u32 s50, s50, 18432
v_add_u32 v45, v45, v44
buffer_load_dwordx4 v[76:79], v45, s[44:47], s50 offen sc1
s_add_u32 s50, s50, 18432
v_add_u32 v45, v45, v44
buffer_load_dwordx4 v[80:83], v45, s[44:47], s50 offen sc1
s_add_u32 s50, s50, 18432
v_add_u32 v45, v45, v44
buffer_load_dwordx4 v[84:87], v45, s[44:47], s50 offen sc1
s_add_u32 s50, s50, 18432
v_add_u32 v45, v45, v44
buffer_load_dwordx4 v[88:91], v45, s[44:47], s50 offen sc1
s_add_u32 s50, s50, 18432
v_add_u32 v45, v45, v44
buffer_load_dwordx4 v[92:95], v45, s[44:47], s50 offen sc1
s_waitcnt vmcnt(0)
v_xor_b32 v4, v49, v10
v_bitop3_b32 v4, v4, v51, v10 bitop3:0xf6
v_bitop3_b32 v4, v4, v53, v10 bitop3:0xf6
v_bitop3_b32 v4, v4, v55, v10 bitop3:0xf6
v_bitop3_b32 v4, v4, v57, v10 bitop3:0xf6
v_bitop3_b32 v4, v4, v59, v10 bitop3:0xf6
v_bitop3_b32 v4, v4, v61, v10 bitop3:0xf6
v_bitop3_b32 v4, v4, v63, v10 bitop3:0xf6
v_bitop3_b32 v4, v4, v65, v10 bitop3:0xf6
v_bitop3_b32 v4, v4, v67, v10 bitop3:0xf6
v_bitop3_b32 v4, v4, v69, v10 bitop3:0xf6
v_bitop3_b32 v4, v4, v71, v10 bitop3:0xf6
v_bitop3_b32 v4, v4, v73, v10 bitop3:0xf6
v_bitop3_b32 v4, v4, v75, v10 bitop3:0xf6
v_bitop3_b32 v4, v4, v77, v10 bitop3:0xf6
v_bitop3_b32 v4, v4, v79, v10 bitop3:0xf6
v_bitop3_b32 v4, v4, v81, v10 bitop3:0xf6
v_bitop3_b32 v4, v4, v83, v10 bitop3:0xf6
v_bitop3_b32 v4, v4, v85, v10 bitop3:0xf6
v_bitop3_b32 v4, v4, v87, v10 bitop3:0xf6
v_bitop3_b32 v4, v4, v89, v10 bitop3:0xf6
v_bitop3_b32 v4, v4, v91, v10 bitop3:0xf6
v_bitop3_b32 v4, v4, v93, v10 bitop3:0xf6
v_bitop3_b32 v4, v4, v95, v10 bitop3:0xf6
v_cmp_ne_u32 vcc, 0, v4
s_cbranch_vccz L_ok_78
s_sub_u32 s34, s34, 1
s_cbranch_scc0 L_h3c_77
s_branch L_end
L_ok_78:
v_add_f32 v48, v48, v52
v_add_f32 v50, v50, v54
v_add_f32 v56, v56, v60
v_add_f32 v58, v58, v62
v_add_f32 v64, v64, v68
v_add_f32 v66, v66, v70
v_add_f32 v72, v72, v76
v_add_f32 v74, v74, v78
v_add_f32 v80, v80, v84
v_add_f32 v82, v82, v86
v_add_f32 v88, v88, v92
v_add_f32 v90, v90, v94
v_add_f32 v48, v48, v56
v_add_f32 v50, v50, v58
v_add_f32 v64, v64, v72
v_add_f32 v66, v66, v74
v_add_f32 v80, v80, v88
v_add_f32 v82, v82, v90
v_add_f32 v48, v48, v64
v_add_f32 v50, v50, v66
v_add_f32 v48, v48, v80
v_add_f32 v50, v50, v82
s_mov_b64 exec, -1
v_mov_b32 v6, v48
v_mov_b32 v7, v50
v_mov_b32 v4, 987991609
v_mov_b32 v5, 925353388
v_permlane32_swap_b32 v48, v6
v_permlane32_swap_b32 v50, v7
v_mov_b32 v53, 1037226984
v_add_f32 v48, v48, v6
v_add_f32 v50, v50, v7
v_mov_b32 v54, 1075009377
v_readlane_b32 s50, v48, 24
v_lshlrev_b32 v55, 2, v38
s_nop 0
v_fma_f32 v4, s50, v4, v5
v_rsq_f32 v4, v4
s_nop 0
v_mul_f32 v48, v48, v4
v_mul_f32 v50, v50, v4
v_cvt_pk_bf16_f32 v48, v48, v50
v_and_b32 v50, 0xffff0000, v48
v_lshlrev_b32 v48, 16, v48
v_mul_f32 v52, v48, v48
v_fma_f32 v52, v52, v53, v54
v_mul_f32 v52, v52, v48
v_exp_f32 v52, -v52
s_nop 0
v_add_f32 v52, 1.0, v52
v_rcp_f32 v52, v52
s_nop 0
v_mul_f32 v52, v52, v48
v_cvt_pk_bf16_f32 v52, v52, v52
v_lshlrev_b32 v52, 16, v52
v_mul_f32 v52, v52, v50
v_cvt_pk_bf16_f32 v52, v52, v52
s_mov_b64 exec, 0xffffff
ds_write_b32 v55, v52 offset:3840
s_mov_b64 exec, 1
ds_write_b32 v2, v11 offset:48
s_mov_b64 exec, -1
s_mul_i32 s48, s29, 110592
s_add_u32 s48, s48, 1060864
s_lshl_b32 s49, s33, 8
s_add_u32 s49, s49, 667648
L_w_79:
ds_read_b32 v4, v2 offset:96
s_waitcnt lgkmcnt(0)
v_readfirstlane_b32 s35, v4
s_nop 0
s_cmp_ge_u32 s35, 9
s_cbranch_scc1 L_wd_80
s_sub_u32 s34, s34, 1
s_cbranch_scc0 L_w_79
s_branch L_end
L_wd_80:
s_mov_b64 exec, s[60:61]
L_h4a_81:
s_mov_b32 s50, s48
buffer_load_dwordx4 v[48:51], v26, s[44:47], s50 offen sc1
s_add_u32 s50, s50, 18432
buffer_load_dwordx4 v[52:55], v26, s[44:47], s50 offen sc1
s_add_u32 s50, s50, 18432
buffer_load_dwordx4 v[56:59], v26, s[44:47], s50 offen sc1
s_add_u32 s50, s50, 18432
buffer_load_dwordx4 v[60:63], v26, s[44:47], s50 offen sc1
s_add_u32 s50, s50, 18432
buffer_load_dwordx4 v[64:67], v26, s[44:47], s50 offen sc1
s_add_u32 s50, s50, 18432
buffer_load_dwordx4 v[68:71], v26, s[44:47], s50 offen sc1
s_waitcnt vmcnt(0)
v_xor_b32 v4, v49, v10
v_bitop3_b32 v4, v4, v51, v10 bitop3:0xf6
v_bitop3_b32 v4, v4, v53, v10 bitop3:0xf6
v_bitop3_b32 v4, v4, v55, v10 bitop3:0xf6
v_bitop3_b32 v4, v4, v57, v10 bitop3:0xf6
v_bitop3_b32 v4, v4, v59, v10 bitop3:0xf6
v_bitop3_b32 v4, v4, v61, v10 bitop3:0xf6
v_bitop3_b32 v4, v4, v63, v10 bitop3:0xf6
v_bitop3_b32 v4, v4, v65, v10 bitop3:0xf6
v_bitop3_b32 v4, v4, v67, v10 bitop3:0xf6
v_bitop3_b32 v4, v4, v69, v10 bitop3:0xf6
v_bitop3_b32 v4, v4, v71, v10 bitop3:0xf6
v_cmp_ne_u32 vcc, 0, v4
s_cbranch_vccz L_ok_82
s_sub_u32 s34, s34, 1
s_cbranch_scc0 L_h4a_81
s_branch L_end
L_ok_82:
v_add_f32 v48, v48, v52
v_add_f32 v50, v50, v54
v_add_f32 v56, v56, v60
v_add_f32 v58, v58, v62
v_add_f32 v64, v64, v68
v_add_f32 v66, v66, v70
v_add_f32 v48, v48, v56
v_add_f32 v50, v50, v58
v_add_f32 v48, v48, v64
v_add_f32 v50, v50, v66
s_mov_b64 exec, -1
v_mov_b32 v49, v10
v_mov_b32 v51, v10
v_mov_b32 v6, v48
v_mov_b32 v7, v50
s_nop 0
v_permlane16_swap_b32 v48, v6
v_permlane16_swap_b32 v50, v7
s_nop 0
v_add_f32 v48, v48, v6
v_add_f32 v50, v50, v7
v_mov_b32 v6, v48
v_mov_b32 v7, v50
s_nop 0
v_permlane32_swap_b32 v48, v6
v_permlane32_swap_b32 v50, v7
s_nop 0
v_add_f32 v48, v48, v6
v_add_f32 v50, v50, v7
s_mov_b64 exec, 0xffff
buffer_store_dwordx4 v[48:51], v37, s[44:47], s49 offen sc1
s_mov_b64 exec, -1
s_cmp_eq_u32 s29, 0
s_cbranch_scc0 L_Cdone
s_lshl_b32 s48, s94, 8
s_add_u32 s48, s48, 667648
s_mov_b64 exec, s[60:61]
L_h4b_83:
s_mov_b32 s50, s48
buffer_load_dwordx4 v[48:51], v27, s[44:47], s50 offen sc1
s_add_u32 s50, s50, 24576
buffer_load_dwordx4 v[52:55], v27, s[44:47], s50 offen sc1
s_waitcnt vmcnt(0)
v_xor_b32 v4, v49, v10
v_bitop3_b32 v4, v4, v51, v10 bitop3:0xf6
v_bitop3_b32 v4, v4, v53, v10 bitop3:0xf6
v_bitop3_b32 v4, v4, v55, v10 bitop3:0xf6
v_cmp_ne_u32 vcc, 0, v4
s_cbranch_vccz L_ok_84
s_sub_u32 s34, s34, 1
s_cbranch_scc0 L_h4b_83
s_branch L_end
L_ok_84:
v_add_f32 v48, v48, v52
v_add_f32 v50, v50, v54
s_mov_b64 exec, -1
v_mov_b32 v6, v48
v_mov_b32 v7, v50
s_nop 0
v_permlane16_swap_b32 v48, v6
v_permlane16_swap_b32 v50, v7
s_nop 0
v_add_f32 v48, v48, v6
v_add_f32 v50, v50, v7
v_mov_b32 v6, v48
v_mov_b32 v7, v50
s_nop 0
v_permlane32_swap_b32 v48, v6
v_permlane32_swap_b32 v50, v7
s_nop 0
v_add_f32 v48, v48, v6
v_add_f32 v50, v50, v7
v_cvt_pk_bf16_f32 v4, v48, v50
v_lshlrev_b32 v6, 16, v4
v_and_b32 v7, 0xffff0000, v4
v_add_f32 v6, v6, v18
v_add_f32 v7, v7, v19
v_cvt_pk_bf16_f32 v4, v6, v7
s_mov_b64 exec, 0xfff
buffer_store_dword v4, v8, s[36:39], 0 offen
s_mov_b64 exec, -1
L_Cdone:
s_endpgm
L_end:
L_exit:
s_endpgm
.section .rodata,"a"
.p2align 6
.amdhsa_kernel sequential_preLN__sliding_block_cached__glu_gated_geglu__decode_kernel
  .amdhsa_next_free_vgpr 128
  .amdhsa_next_free_sgpr 102
  .amdhsa_accum_offset 128
  .amdhsa_group_segment_fixed_size 0
  .amdhsa_kernarg_size 96
  .amdhsa_user_sgpr_count 2
  .amdhsa_user_sgpr_kernarg_segment_ptr 1
  .amdhsa_system_sgpr_workgroup_id_x 1
.end_amdhsa_kernel
```
